```python
import torch

def _softmax(x, axis=-1):
    return torch.softmax(x, dim=axis)
def _gelu(x):
    return torch.nn.functional.gelu(x, approximate="tanh")
def _silu(x):
    return torch.nn.functional.silu(x)
def _sigmoid(x):
    return torch.sigmoid(x)
def _layernorm(x, axis=-1, eps=1e-5):
    m = x.mean(dim=axis, keepdim=True)
    v = x.var(dim=axis, keepdim=True, unbiased=False)
    return (x - m) / torch.sqrt(v + eps)
def _scatter_add(tgt, idx, src, axis=0):
    return tgt.clone().index_add_(axis, idx, src)
def _segment_sum(src, seg, n):
    out = torch.zeros((n,) + src.shape[1:], dtype=src.dtype)
    return out.index_add_(0, seg, src)
def _pad(x, pw):
    flat = tuple(v for pair in reversed(pw) for v in pair)
    return torch.nn.functional.pad(x, flat)

kernel_name = 'gated_mix__sliding_local_dilated__softmax_full_mha__prompt'

def setup_inputs():

    _w = (lambda a: (lambda t: t.to(torch.bfloat16) if t.is_floating_point() else t)(torch.as_tensor(a)))
    def _A_setup():
        B, S, D = 1, 2048, 512
        return {
            "x": _w((lambda *s: torch.randn(*s, dtype=torch.bfloat16) * 0.05)(B, S, D)),
            "wqkv": _w((lambda *s: torch.randn(*s, dtype=torch.bfloat16) * 1.6)(D, 3 * D)),
            "wo": _w((lambda *s: torch.randn(*s, dtype=torch.bfloat16) * 0.05)(D, D)),
        }
    _A_in = _A_setup()

    def _B_setup():
        B, S, D = 1, 2048, 512
        return {
            "x": _w((lambda *s: torch.randn(*s, dtype=torch.bfloat16) * 0.05)(B, S, D)),
            "wqkv": _w((lambda *s: torch.randn(*s, dtype=torch.bfloat16) * 1.6)(D, 3 * D)),
            "wo": _w((lambda *s: torch.randn(*s, dtype=torch.bfloat16) * 0.1)(D, D)),
        }
    _B_in = _B_setup()

    return {
        "A_x": _A_in["x"],
        "A_wqkv": _A_in["wqkv"],
        "A_wo": _A_in["wo"],
        "B_x": _B_in["x"],
        "B_wqkv": _B_in["wqkv"],
        "B_wo": _B_in["wo"],
        "gate_w": _w((lambda *s: torch.randn(*s, dtype=torch.bfloat16) * 0.05)(512) * 16.0),
    }

def reference(A_x, A_wqkv, A_wo, B_x, B_wqkv, B_wo, gate_w):
    def _A_ref(x, wqkv, wo):
        B, S, D = x.shape
        H = 32; Dh = D // H
        W, dil = 8, 2
        qkv = (lambda x, *d: x.permute(*d))((x @ wqkv).reshape(B, S, 3, H, Dh), 2, 0, 3, 1, 4)
        q, k, v = qkv[0], qkv[1], qkv[2]
        scale = Dh ** -0.5
        pos = torch.arange(S)
        off = torch.arange(W) * dil
        idx = pos[:, None] - off[None, :]
        mask = idx >= 0
        idx_c = torch.where(mask, idx, 0).reshape(-1)
        kg = k[:, :, idx_c, :].reshape(B, H, S, W, Dh)
        vg = v[:, :, idx_c, :].reshape(B, H, S, W, Dh)
        logits = torch.einsum("bhsd,bhswd->bhsw", q, kg) * scale
        logits = torch.where(mask[None, None, :, :], logits, -1e9)
        attn = _softmax(logits, axis=-1)
        o = torch.einsum("bhsw,bhswd->bhsd", attn, vg)
        return (lambda x, *d: x.permute(*d))(o, 0, 2, 1, 3).reshape(B, S, D) @ wo

    def _B_ref(x, wqkv, wo):
        B, S, D = x.shape
        H = 32; Dh = D // H
        qkv = (lambda x, *d: x.permute(*d))((x @ wqkv).reshape(B, S, 3, H, Dh), 2, 0, 3, 1, 4)
        q, k, v = qkv[0], qkv[1], qkv[2]
        scale = Dh ** -0.5
        scores = torch.einsum("bhqd,bhkd->bhqk", q, k) * scale
        p = _softmax(scores, axis=-1)
        o = torch.einsum("bhqk,bhkd->bhqd", p, v)
        return (lambda x, *d: x.permute(*d))(o, 0, 2, 1, 3).reshape(B, S, D) @ wo

    x = A_x
    g = _sigmoid((x * gate_w).sum(-1, keepdims=True))
    a = _A_ref(x, A_wqkv, A_wo)
    b = _B_ref(x, B_wqkv, B_wo)
    return g * a + (1 - g) * b
```

```asm
; @launch grid=(256,1,1) block=(512,1,1) lds=163840
.amdgcn_target "amdgcn-amd-amdhsa--gfx950"
.text
.p2align 8
.globl gated_mix__sliding_local_dilated__softmax_full_mha__prompt_kernel
.type gated_mix__sliding_local_dilated__softmax_full_mha__prompt_kernel,@function
gated_mix__sliding_local_dilated__softmax_full_mha__prompt_kernel:
    s_cmp_ge_u32 s2, 256
    s_cbranch_scc1 L_end
    s_load_dwordx16 s[36:51], s[0:1], 0
    s_load_dwordx4 s[52:55], s[0:1], 64
    v_lshrrev_b32 v2, 6, v0
    v_and_b32 v1, 63, v0
    v_readfirstlane_b32 s20, v2
    v_lshlrev_b32 v2, 4, v1
    s_and_b32 s26, s2, 7
    s_lshr_b32 s27, s2, 3
    s_and_b32 s23, s26, 1
    s_lshl_b32 s23, s23, 4
    s_and_b32 s28, s27, 15
    s_add_u32 s23, s23, s28
    s_lshr_b32 s24, s26, 1
    s_xor_b32 s24, s24, 3
    s_lshr_b32 s28, s27, 4
    s_lshl_b32 s28, s28, 2
    s_add_u32 s24, s24, s28
    s_add_u32 s25, s27, s28
    s_and_b32 s25, s27, 3
    s_and_b32 s28, s26, 1
    s_lshl1_add_u32 s25, s25, s28
    s_lshl_b32 s25, s25, 7
    v_mov_b32 v139, 0
    s_getpc_b64 s[98:99]
L_pc:
    s_sub_u32 s98, s98, L_pc-gated_mix__sliding_local_dilated__softmax_full_mha__prompt_kernel
    s_subb_u32 s99, s99, 0
    s_and_b32 s100, s2, 0xf8
    s_add_u32 s100, s100, s20
    s_lshl_b32 s100, s100, 8
    s_min_u32 s100, s100, L_code_end-gated_mix__sliding_local_dilated__softmax_full_mha__prompt_kernel-132
    s_cmp_ge_u32 s20, 4
    s_cbranch_scc0 L_compute
    s_setprio 2
    s_sub_u32 s29, s20, 4
    v_lshrrev_b32 v6, 3, v1
    v_lshrrev_b32 v7, 4, v1
    v_and_b32 v8, 7, v1
    v_xor_b32 v9, v8, v7
    v_xor_b32 v10, 4, v9
    v_lshlrev_b32 v3, 11, v6
    v_lshl_add_u32 v4, v10, 4, v3
    v_lshl_add_u32 v3, v9, 4, v3
    v_and_b32 v7, 1, v7
    v_lshlrev_b32 v7, 2, v7
    v_xor_b32 v7, v8, v7
    v_mul_u32_u24 v5, 3072, v6
    v_lshl_add_u32 v5, v7, 4, v5
    s_lshr_b32 s28, s29, 1
    s_lshl_b32 s30, s23, 6
    s_add_u32 s30, s30, s28
    s_lshl_b32 s30, s30, 10
    s_lshl_b32 s31, s28, 12
    s_and_b32 s28, s29, 1
    s_lshl_b32 s33, s28, 15
    s_add_u32 s30, s30, s33
    s_lshl_b32 s33, s28, 11
    s_add_u32 s31, s31, s33
    s_mul_i32 s32, s29, 49152
    s_lshl_b32 s28, s24, 7
    s_add_u32 s32, s32, s28
    s_lshl_b32 s33, s29, 11
    s_add_u32 s33, s33, 65536
    s_mov_b32 s58, 0
    s_mov_b32 s6, 0x200000
    s_mov_b32 s7, 0x00020000
    s_mov_b32 s10, 0x180000
    s_mov_b32 s11, 0x00020000
    s_mov_b32 s14, 16777216
    s_mov_b32 s15, 0x00020000
    s_waitcnt lgkmcnt(0)
    s_mov_b32 s4, s36
    s_mov_b32 s5, s37
    s_mov_b32 s8, s44
    s_mov_b32 s9, s45
    s_mov_b32 s12, s54
    s_mov_b32 s13, s55
    s_load_dword s101, s[98:99], s100
    s_load_dword s101, s[98:99], s100 offset:128
L_ldB:
    s_mul_i32 s34, s25, 1536
    s_add_u32 s35, s30, s25
    s_mov_b32 m0, s31
    s_add_u32 s34, s34, s32
    buffer_load_dwordx4 v3, s[4:7], s35 offen lds
    s_add_u32 m0, s31, 1024
    s_add_u32 s28, s35, 16384
    buffer_load_dwordx4 v4, s[4:7], s28 offen lds
    s_add_u32 m0, s33, 0
    s_add_u32 s28, s34, 0
    buffer_load_dwordx4 v5, s[8:11], s28 offen lds
    s_add_u32 m0, s33, 1024
    s_add_u32 s28, s34, 24576
    buffer_load_dwordx4 v5, s[8:11], s28 offen lds
    s_add_u32 m0, s33, 8192
    s_add_u32 s28, s34, 1024
    buffer_load_dwordx4 v5, s[8:11], s28 offen lds
    s_add_u32 m0, s33, 9216
    s_add_u32 s28, s34, 25600
    buffer_load_dwordx4 v5, s[8:11], s28 offen lds
    s_add_u32 m0, s33, 16384
    s_add_u32 s28, s34, 2048
    buffer_load_dwordx4 v5, s[8:11], s28 offen lds
    s_add_u32 m0, s33, 17408
    s_add_u32 s28, s34, 26624
    buffer_load_dwordx4 v5, s[8:11], s28 offen lds
    s_add_u32 s31, s31, 8192
    s_add_u32 s25, s25, 128
    s_and_b32 s25, s25, 1023
    s_add_u32 s33, s33, 24576
    s_cmp_ge_u32 s33, 163840
    s_cselect_b32 s28, 98304, 0
    s_sub_u32 s33, s33, s28
    s_add_u32 s58, s58, 1
    s_cmp_lt_u32 s58, 3
    s_cbranch_scc1 L_ldB
    s_waitcnt vmcnt(16)
    s_barrier
    s_cmp_lt_u32 s58, 8
    s_cbranch_scc1 L_ldB
    s_mov_b64 s[8:9], s[38:39]
    v_mov_b32 v12, 0
    v_mov_b32 v31, 0
    s_mov_b32 s59, 0
L_ldA:
    s_mul_i32 s34, s25, 1536
    s_add_u32 s34, s34, s32
    s_add_u32 m0, s33, 0
    s_add_u32 s28, s34, 0
    buffer_load_dwordx4 v5, s[8:11], s28 offen lds
    s_add_u32 m0, s33, 1024
    s_add_u32 s28, s34, 24576
    buffer_load_dwordx4 v5, s[8:11], s28 offen lds
    s_add_u32 m0, s33, 8192
    s_add_u32 s28, s34, 1024
    buffer_load_dwordx4 v5, s[8:11], s28 offen lds
    s_add_u32 m0, s33, 9216
    s_add_u32 s28, s34, 25600
    buffer_load_dwordx4 v5, s[8:11], s28 offen lds
    s_add_u32 m0, s33, 16384
    s_add_u32 s28, s34, 2048
    buffer_load_dwordx4 v5, s[8:11], s28 offen lds
    s_add_u32 m0, s33, 17408
    s_add_u32 s28, s34, 26624
    buffer_load_dwordx4 v5, s[8:11], s28 offen lds
    s_add_u32 s25, s25, 128
    s_and_b32 s25, s25, 1023
    s_add_u32 s33, s33, 24576
    s_cmp_ge_u32 s33, 163840
    s_cselect_b32 s28, 98304, 0
    s_sub_u32 s33, s33, s28
    s_add_u32 s58, s58, 1
    s_cmp_eq_u32 s58, 12
    s_cbranch_scc1 L_lsetup
L_lsetup_ret:
    s_waitcnt vmcnt(12)
    s_barrier
    s_cmp_lt_u32 s58, 16
    s_cbranch_scc1 L_ldA
    s_mov_b32 exec_lo, 0xffff
    s_mov_b32 exec_hi, 0
    v_mov_b32 v14, -1
    buffer_load_dword v14, v12, s[12:15], s45 offen sc1
    s_mov_b64 exec, -1
    v_and_b32 v24, 31, v1
    v_lshrrev_b32 v25, 5, v1
    v_lshlrev_b32 v6, 4, v24
    v_lshl_add_u32 v6, v25, 8, v6
    v_mov_b32 v5, 2048
    v_and_b32 v26, 27, v24
    v_mov_b32 v27, 0x40000
    v_cmp_eq_u32 vcc, 16, v26
    s_mov_b32 s38, 0
    s_nop 0
    v_cndmask_b32 v5, v27, v5, vcc
    v_cmp_gt_u32 vcc, 16, v24
    v_add_u32 v3, 1024, v6
    v_add_u32 v4, 1536, v6
    v_cndmask_b32 v3, v5, v3, vcc
    v_cndmask_b32 v4, v5, v4, vcc
    v_lshrrev_b32 v24, 1, v2
    v_xor_b32 v24, v24, v2
    v_and_b32 v24, 64, v24
    v_mul_u32_u24 v24, 3, v24
    v_xor_b32 v5, v24, v2
    s_waitcnt vmcnt(1)
    s_barrier
    s_mov_b32 exec_lo, 0x3fffe
    s_mov_b32 exec_hi, 0
    ds_write_b128 v28, v[32:35] offset:2048
    s_mov_b64 exec, -1
L_pw:
    v_cmp_eq_u32 vcc, -1, v14
    s_add_u32 s47, s47, 1
    s_cmp_gt_u32 s47, 160000
    s_cbranch_scc1 L_pforce
    s_cbranch_vccz L_pgot
    s_sleep 1
    s_branch L_pw
L_pforce:
    s_mov_b32 s43, 0x5555
    s_mov_b32 s35, 0
    s_branch L_pq
L_pgot:
    v_add_u32 v29, -1, v14
    v_cmp_gt_u32 vcc, 3, v29
    s_nop 0
    s_lshr_b32 s28, vcc_lo, 1
    s_and_b32 s43, s28, vcc_lo
    s_and_b32 s43, s43, 0x5555
    s_and_b32 s34, s43, s42
    s_bcnt1_i32_b32 s35, s34
    s_add_u32 s35, s35, s44
    s_cmp_lt_u32 s35, 2
    s_cselect_b32 s35, 0x5555, s46
    s_andn2_b32 s35, s35, s43
    s_mul_i32 s35, s35, 3
    s_cmp_eq_u32 s35, 0
    s_cbranch_scc1 L_pq
    s_mov_b32 exec_lo, s35
    s_mov_b32 exec_hi, 0
    v_mov_b32 v14, -1
    buffer_load_dword v14, v12, s[12:15], s45 offen sc1
    s_mov_b64 exec, -1
L_pq:
    s_and_b32 s28, s43, s61
    s_cbranch_scc0 L_pp
    s_mov_b64 exec, 1
    ds_write_b32 v13, v32
    s_mov_b64 exec, -1
    buffer_load_dwordx4 v[8:11], v2, s[12:15], s30 offen sc1
    s_mov_b32 s61, 0
L_pp:
    s_cmp_ge_u32 s44, 2
    s_cbranch_scc1 L_pe
    s_and_b32 s34, s43, s42
    s_cbranch_scc0 L_pe
    s_mov_b32 m0, s41
    s_ff1_i32_b32 s28, s34
    s_bitset0_b32 s42, s28
    s_lshl_b32 s28, s28, 13
    s_add_u32 s33, s28, s40
    buffer_load_dwordx4 v2, s[12:15], s33 offen sc1 lds
    buffer_load_dwordx4 v2, s[12:15], s33 offen offset:1024 sc1 lds
    s_add_u32 m0, s41, 16
    s_add_u32 s41, s41, 16512
    buffer_load_dwordx4 v2, s[12:15], s33 offen offset:2048 sc1 lds
    buffer_load_dwordx4 v2, s[12:15], s33 offen offset:3072 sc1 lds
    s_add_u32 s44, s44, 1
    s_branch L_pp
L_pe:
    s_cmp_lg_u32 s35, 0
    s_cbranch_scc1 L_pw
    s_andn2_b32 s35, 0x5555, s43
    s_mul_i32 s35, s35, 3
    s_cmp_eq_u32 s35, 0
    s_waitcnt vmcnt(0) lgkmcnt(0)
    s_cbranch_scc1 L_nosf
    s_mov_b32 exec_lo, s35
    s_mov_b32 exec_hi, 0
    v_mov_b32 v30, -1
    buffer_load_dword v30, v31, s[12:15], s45 offen sc1
    s_mov_b64 exec, -1
L_nosf:
    s_barrier
    s_setprio 3
    s_mov_b32 exec_lo, 0xfffc0000
    ds_write_b128 v28, v[32:35] offset:2048
    s_mov_b32 exec_lo, -1
    s_branch L_main
L_lsetup:
    s_lshl_b32 s21, s26, 2
    s_and_b32 s75, s27, 3
    s_add_u32 s21, s21, s75
    s_lshr_b32 s22, s27, 2
    s_lshl_b32 s56, s22, 2
    s_and_b32 s75, s20, 3
    s_add_u32 s56, s56, s75
    s_lshl_b32 s56, s56, 1
    s_lshr_b32 s75, s20, 2
    s_add_u32 s56, s56, s75
    s_lshl_b32 s57, s56, 15
    s_lshl_b32 s75, s21, 10
    s_add_u32 s57, s57, s75
    s_add_u32 s57, s57, 12582912
    s_lshl_b32 s30, s21, 16
    s_lshl_b32 s28, s56, 10
    s_add_u32 s30, s30, s28
    s_lshl_b32 s40, s21, 17
    s_lshl_b32 s28, s29, 12
    s_add_u32 s40, s40, s28
    s_add_u32 s40, s40, 2097152
    s_mul_i32 s41, s29, 4128
    s_mov_b32 s42, 0x5555
    s_mov_b32 s44, 0
    s_mov_b32 s47, 0
    s_lshl_b32 s28, s22, 1
    s_lshl_b32 s46, 1, s28
    s_mov_b32 s61, s46
    s_and_b32 s45, s26, 6
    s_and_b32 s28, s26, 1
    s_lshl_b32 s28, s28, 7
    s_add_u32 s45, s45, s28
    s_lshl_b32 s28, s29, 3
    s_add_u32 s45, s45, s28
    s_lshl_b32 s45, s45, 7
    s_and_b32 s28, s21, 2
    s_lshl_b32 s28, s28, 2
    s_add_u32 s45, s45, s28
    s_add_u32 s45, s45, 15990784
    v_bfe_u32 v12, v1, 3, 1
    v_lshlrev_b32 v12, 7, v12
    v_bfe_u32 v13, v1, 1, 2
    v_lshl_add_u32 v12, v13, 12, v12
    v_and_b32 v13, 1, v1
    v_lshl_add_u32 v12, v13, 2, v12
    v_mov_b32 v31, v12
    s_lshl_b32 s28, s29, 2
    s_add_u32 s28, s28, 2048
    v_mov_b32 v13, s28
    v_mov_b32 v14, 0
    v_mov_b32 v15, 0
    v_mov_b32 v30, 0
    v_mul_u32_u24 v28, 2064, v1
    v_mov_b32 v32, 0x3f803f80
    v_mov_b32 v33, 0x3f803f80
    v_mov_b32 v34, 0x3f803f80
    v_mov_b32 v35, 0x3f803f80
    s_branch L_lsetup_ret
L_compute:
    s_setprio 3
    s_and_b32 s28, s20, 1
    s_lshr_b32 s29, s20, 1
    s_lshl_b32 s58, s23, 1
    s_add_u32 s58, s58, s28
    s_lshl_b32 s59, s24, 1
    s_add_u32 s59, s59, s29
    v_and_b32 v7, 31, v1
    v_lshrrev_b32 v8, 5, v1
    s_lshl_b32 s30, s2, 12
    s_add_u32 s30, s30, 15990784
    v_mov_b64 v[24:25], 0
    v_mov_b64 v[26:27], 0
    v_bfe_u32 v9, v1, 1, 3
    v_lshlrev_b32 v9, 5, v9
    v_lshl_add_u32 v9, v8, 4, v9
    v_add_u32 v9, s25, v9
    v_lshrrev_b32 v10, 4, v1
    v_xor_b32 v10, v10, v1
    v_and_b32 v10, 1, v10
    v_add_u32 v224, 0, v9
    v_and_b32 v224, 1023, v224
    v_lshl_add_u32 v224, v10, 16, v224
    v_add_u32 v225, 256, v9
    v_and_b32 v225, 1023, v225
    v_lshl_add_u32 v225, v10, 16, v225
    v_add_u32 v226, 512, v9
    v_and_b32 v226, 1023, v226
    v_lshl_add_u32 v226, v10, 16, v226
    v_add_u32 v227, 768, v9
    v_and_b32 v227, 1023, v227
    v_lshl_add_u32 v227, v10, 16, v227
    s_mov_b32 s6, 1024
    s_mov_b32 s7, 0x00020000
    s_mov_b32 s14, 16777216
    s_mov_b32 s15, s7
    s_movk_i32 s10, 256
    s_mov_b32 s11, s7
    s_waitcnt lgkmcnt(0)
    s_mov_b64 s[12:13], s[54:55]
    s_mov_b64 s[8:9], s[52:53]
    s_mov_b64 s[4:5], s[48:49]
    s_lshl_b32 s31, s20, 8
    s_add_u32 s31, s31, s2
    s_sub_u32 s31, s31, 256
    s_cmp_lt_u32 s31, 8
    s_cselect_b32 s63, 1, 0
    s_cbranch_scc0 L_noinit1
    buffer_store_dwordx4 v[24:27], v2, s[12:15], s30 offen offset:0 sc1
    buffer_store_dwordx4 v[24:27], v2, s[12:15], s30 offen offset:1024 sc1
    buffer_store_dwordx4 v[24:27], v2, s[12:15], s30 offen offset:2048 sc1
    buffer_store_dwordx4 v[24:27], v2, s[12:15], s30 offen offset:3072 sc1
L_noinit1:
    buffer_load_dwordx4 v[128:131], v224, s[4:7], 0 offen
    buffer_load_dwordx4 v[116:119], v225, s[4:7], 0 offen
    buffer_load_dwordx4 v[120:123], v226, s[4:7], 0 offen
    buffer_load_dwordx4 v[124:127], v227, s[4:7], 0 offen
    s_load_dword s101, s[98:99], s100
    s_load_dword s101, s[98:99], s100 offset:128
    s_cbranch_scc0 L_noinit
    v_mov_b32 v12, 1
    s_lshl_b32 s31, s2, 2
    s_mov_b64 exec, 1
    s_waitcnt vmcnt(4)
    buffer_store_dword v12, v139, s[8:11], s31 offen sc1
    s_mov_b64 exec, -1
L_noinit:
    v_bfe_u32 v9, v1, 1, 3
    v_xor_b32 v9, v9, v8
    v_lshlrev_b32 v9, 4, v9
    s_lshl_b32 s30, s28, 12
    v_lshlrev_b32 v3, 7, v7
    v_add_u32 v3, s30, v3
    v_xor_b32 v4, 32, v9
    v_xor_b32 v5, 64, v9
    v_xor_b32 v6, 96, v9
    v_add_u32 v4, v3, v4
    v_add_u32 v5, v3, v5
    v_add_u32 v6, v3, v6
    v_add_u32 v3, v3, v9
    v_bfe_u32 v9, v1, 2, 2
    v_lshl_add_u32 v13, v8, 3, v9
    v_lshlrev_b32 v13, 7, v13
    v_bfe_u32 v10, v1, 3, 1
    v_xor_b32 v10, s29, v10
    v_lshl_add_u32 v13, v10, 6, v13
    v_bfe_u32 v10, v1, 4, 1
    v_and_b32 v11, 3, v1
    v_lshl_add_u32 v13, v10, 5, v13
    v_lshl_add_u32 v13, v11, 3, v13
    v_add_u32 v13, 65536, v13
    s_mov_b32 s34, 65536
    s_mov_b32 s35, 0
    s_barrier
    ds_read_b128 v[80:83], v3
    ds_read_b64_tr_b16 v[84:85], v13 offset:0
    ds_read_b64_tr_b16 v[86:87], v13 offset:512
    ds_read_b64_tr_b16 v[88:89], v13 offset:8192
    ds_read_b64_tr_b16 v[90:91], v13 offset:8704
    ds_read_b64_tr_b16 v[92:93], v13 offset:16384
    ds_read_b64_tr_b16 v[94:95], v13 offset:16896
    ds_read_b128 v[96:99], v4
    ds_read_b64_tr_b16 v[100:101], v13 offset:2048
    ds_read_b64_tr_b16 v[102:103], v13 offset:2560
    ds_read_b64_tr_b16 v[104:105], v13 offset:10240
    ds_read_b64_tr_b16 v[106:107], v13 offset:10752
    ds_read_b64_tr_b16 v[108:109], v13 offset:18432
    ds_read_b64_tr_b16 v[110:111], v13 offset:18944
    s_waitcnt vmcnt(1)
    s_cmp_eq_u32 s63, 1
    s_cbranch_scc1 L_cB0
    s_waitcnt vmcnt(0)
L_cB0:
    s_waitcnt lgkmcnt(7)
    v_mfma_f32_32x32x16_bf16 v[48:63], v[88:91], v[80:83], 0
    ds_read_b128 v[192:195], v5
    ds_read_b64_tr_b16 v[196:197], v13 offset:4096
    ds_read_b64_tr_b16 v[198:199], v13 offset:4608
    ds_read_b64_tr_b16 v[200:201], v13 offset:12288
    s_cmp_lt_u32 s58, 32
    s_cselect_b32 s16, s40, s46
    s_cselect_b32 s17, s41, s47
    s_mov_b32 s18, 0x80000
    v_mfma_f32_32x32x16_bf16 v[64:79], v[80:83], v[92:95], 0
    ds_read_b64_tr_b16 v[202:203], v13 offset:12800
    ds_read_b64_tr_b16 v[204:205], v13 offset:20480
    ds_read_b64_tr_b16 v[206:207], v13 offset:20992
    s_mov_b32 s19, s7
    v_and_b32 v19, 7, v1
    v_mfma_f32_32x32x16_bf16 v[32:47], v[84:87], v[80:83], 0
    v_lshlrev_b32 v19, 2, v19
    v_lshrrev_b32 v12, 2, v1
    v_mfma_f32_16x16x32_bf16 v[224:227], v[128:131], v[80:83], 0
    s_waitcnt lgkmcnt(7)
    v_mfma_f32_32x32x16_bf16 v[48:63], v[104:107], v[96:99], v[48:63]
    ds_read_b128 v[208:211], v6
    ds_read_b64_tr_b16 v[212:213], v13 offset:6144
    ds_read_b64_tr_b16 v[214:215], v13 offset:6656
    ds_read_b64_tr_b16 v[216:217], v13 offset:14336
    v_lshlrev_b32 v12, 10, v12
    v_lshl_add_u32 v138, v11, 4, v12
    v_mfma_f32_32x32x16_bf16 v[64:79], v[96:99], v[108:111], v[64:79]
    ds_read_b64_tr_b16 v[218:219], v13 offset:14848
    ds_read_b64_tr_b16 v[220:221], v13 offset:22528
    ds_read_b64_tr_b16 v[222:223], v13 offset:23040
    s_add_u32 s34, s34, 24576
    s_cmp_ge_u32 s34, 163840
    s_cselect_b32 s28, 98304, 0
    s_sub_u32 s34, s34, s28
    s_sub_u32 s28, 24576, s28
    s_add_u32 s35, s35, 1
    s_cmp_eq_u32 s35, 8
    s_cselect_b32 s29, -65536, 0
    s_add_u32 s29, s29, 8192
    v_add_u32 v13, s28, v13
    v_add_u32 v3, s29, v3
    v_add_u32 v4, s29, v4
    v_add_u32 v5, s29, v5
    v_add_u32 v6, s29, v6
    s_and_b32 s76, s58, 31
    s_lshl_b32 s48, s76, 14
    v_mfma_f32_32x32x16_bf16 v[32:47], v[100:103], v[96:99], v[32:47]
    s_lshl_b32 s75, s59, 6
    s_add_u32 s48, s48, s75
    v_mfma_f32_16x16x32_bf16 v[228:231], v[128:131], v[96:99], 0
    s_waitcnt lgkmcnt(0)
    s_barrier
    v_mfma_f32_32x32x16_bf16 v[48:63], v[200:203], v[192:195], v[48:63]
    ds_read_b128 v[80:83], v3
    ds_read_b64_tr_b16 v[84:85], v13 offset:0
    ds_read_b64_tr_b16 v[86:87], v13 offset:512
    ds_read_b64_tr_b16 v[88:89], v13 offset:8192
    s_lshl_b32 s49, s20, 10
    s_add_u32 s49, s49, 156672
    v_mfma_f32_32x32x16_bf16 v[64:79], v[192:195], v[204:207], v[64:79]
    ds_read_b64_tr_b16 v[90:91], v13 offset:8704
    ds_read_b64_tr_b16 v[92:93], v13 offset:16384
    ds_read_b64_tr_b16 v[94:95], v13 offset:16896
    v_lshl_add_u32 v12, v8, 2, v9
    v_lshlrev_b32 v12, 6, v12
    v_lshl_add_u32 v12, v10, 5, v12
    v_mfma_f32_32x32x16_bf16 v[32:47], v[196:199], v[192:195], v[32:47]
    v_lshl_add_u32 v12, v11, 3, v12
    v_add_u32 v140, s49, v12
    v_mfma_f32_16x16x32_bf16 v[232:235], v[128:131], v[192:195], 0
    v_mfma_f32_32x32x16_bf16 v[48:63], v[216:219], v[208:211], v[48:63]
    ds_read_b128 v[96:99], v4
    ds_read_b64_tr_b16 v[100:101], v13 offset:2048
    ds_read_b64_tr_b16 v[102:103], v13 offset:2560
    ds_read_b64_tr_b16 v[104:105], v13 offset:10240
    v_lshlrev_b32 v18, 17, v10
    v_lshl_add_u32 v18, v8, 8, v18
    v_mfma_f32_32x32x16_bf16 v[64:79], v[208:211], v[220:223], v[64:79]
    ds_read_b64_tr_b16 v[106:107], v13 offset:10752
    ds_read_b64_tr_b16 v[108:109], v13 offset:18432
    ds_read_b64_tr_b16 v[110:111], v13 offset:18944
    v_and_b32 v9, 15, v1
    v_lshl_add_u32 v18, v9, 4, v18
    v_mfma_f32_32x32x16_bf16 v[32:47], v[212:215], v[208:211], v[32:47]
    s_lshr_b32 s47, s58, 5
    s_lshl_b32 s47, s47, 4
    v_mfma_f32_16x16x32_bf16 v[236:239], v[128:131], v[208:211], 0
    s_waitcnt lgkmcnt(7)
    v_mfma_f32_32x32x16_bf16 v[48:63], v[88:91], v[80:83], v[48:63]
    ds_read_b128 v[192:195], v5
    ds_read_b64_tr_b16 v[196:197], v13 offset:4096
    ds_read_b64_tr_b16 v[198:199], v13 offset:4608
    ds_read_b64_tr_b16 v[200:201], v13 offset:12288
    s_add_u32 s47, s47, s59
    s_lshl_b32 s47, s47, 5
    v_mfma_f32_32x32x16_bf16 v[64:79], v[80:83], v[92:95], v[64:79]
    ds_read_b64_tr_b16 v[202:203], v13 offset:12800
    ds_read_b64_tr_b16 v[204:205], v13 offset:20480
    ds_read_b64_tr_b16 v[206:207], v13 offset:20992
    s_add_u32 s47, s47, s76
    s_lshl_b32 s47, s47, 10
    v_mfma_f32_32x32x16_bf16 v[32:47], v[84:87], v[80:83], v[32:47]
    s_add_u32 s47, s47, 14680064
    s_cmp_eq_u32 s20, 0
    s_cselect_b32 s46, 1, 0
    v_mfma_f32_16x16x32_bf16 v[240:243], v[128:131], v[80:83], 0
    s_waitcnt lgkmcnt(7)
    v_mfma_f32_32x32x16_bf16 v[48:63], v[104:107], v[96:99], v[48:63]
    ds_read_b128 v[208:211], v6
    ds_read_b64_tr_b16 v[212:213], v13 offset:6144
    ds_read_b64_tr_b16 v[214:215], v13 offset:6656
    ds_read_b64_tr_b16 v[216:217], v13 offset:14336
    s_lshl_b32 s75, s20, 2
    s_add_u32 s75, s75, 2048
    v_mov_b32 v7, s75
    v_mfma_f32_32x32x16_bf16 v[64:79], v[96:99], v[108:111], v[64:79]
    ds_read_b64_tr_b16 v[218:219], v13 offset:14848
    ds_read_b64_tr_b16 v[220:221], v13 offset:22528
    ds_read_b64_tr_b16 v[222:223], v13 offset:23040
    s_add_u32 s34, s34, 24576
    s_cmp_ge_u32 s34, 163840
    s_cselect_b32 s28, 98304, 0
    s_sub_u32 s34, s34, s28
    s_sub_u32 s28, 24576, s28
    s_add_u32 s35, s35, 1
    s_cmp_eq_u32 s35, 8
    s_cselect_b32 s29, -65536, 0
    s_add_u32 s29, s29, 8192
    v_add_u32 v13, s28, v13
    v_add_u32 v3, s29, v3
    v_add_u32 v4, s29, v4
    v_add_u32 v5, s29, v5
    v_add_u32 v6, s29, v6
    v_mov_b32 v31, 0
    s_lshl_b32 s61, s58, 4
    v_mfma_f32_32x32x16_bf16 v[32:47], v[100:103], v[96:99], v[32:47]
    s_add_u32 s61, s61, s59
    s_lshl_b32 s21, s26, 2
    v_mfma_f32_16x16x32_bf16 v[244:247], v[128:131], v[96:99], 0
    s_waitcnt lgkmcnt(0)
    s_barrier
    v_mfma_f32_32x32x16_bf16 v[48:63], v[200:203], v[192:195], v[48:63]
    ds_read_b128 v[80:83], v3
    ds_read_b64_tr_b16 v[84:85], v13 offset:0
    ds_read_b64_tr_b16 v[86:87], v13 offset:512
    ds_read_b64_tr_b16 v[88:89], v13 offset:8192
    s_and_b32 s75, s27, 3
    s_add_u32 s21, s21, s75
    v_mfma_f32_32x32x16_bf16 v[64:79], v[192:195], v[204:207], v[64:79]
    ds_read_b64_tr_b16 v[90:91], v13 offset:8704
    ds_read_b64_tr_b16 v[92:93], v13 offset:16384
    ds_read_b64_tr_b16 v[94:95], v13 offset:16896
    s_lshr_b32 s22, s27, 2
    s_lshl_b32 s56, s22, 2
    v_mfma_f32_32x32x16_bf16 v[32:47], v[196:199], v[192:195], v[32:47]
    s_and_b32 s75, s20, 3
    s_add_u32 s56, s56, s75
    v_mfma_f32_16x16x32_bf16 v[248:251], v[128:131], v[192:195], 0
    v_mfma_f32_32x32x16_bf16 v[48:63], v[216:219], v[208:211], v[48:63]
    ds_read_b128 v[96:99], v4
    ds_read_b64_tr_b16 v[100:101], v13 offset:2048
    ds_read_b64_tr_b16 v[102:103], v13 offset:2560
    ds_read_b64_tr_b16 v[104:105], v13 offset:10240
    s_lshl_b32 s56, s56, 1
    s_lshr_b32 s75, s20, 2
    v_mfma_f32_32x32x16_bf16 v[64:79], v[208:211], v[220:223], v[64:79]
    ds_read_b64_tr_b16 v[106:107], v13 offset:10752
    ds_read_b64_tr_b16 v[108:109], v13 offset:18432
    ds_read_b64_tr_b16 v[110:111], v13 offset:18944
    s_add_u32 s56, s56, s75
    s_lshl_b32 s57, s56, 15
    v_mfma_f32_32x32x16_bf16 v[32:47], v[212:215], v[208:211], v[32:47]
    s_lshl_b32 s75, s21, 10
    s_add_u32 s57, s57, s75
    s_add_u32 s57, s57, 12582912
    v_mfma_f32_16x16x32_bf16 v[252:255], v[128:131], v[208:211], 0
L_cB:
    s_waitcnt lgkmcnt(7)
    v_mfma_f32_32x32x16_bf16 v[48:63], v[88:91], v[80:83], v[48:63]
    ds_read_b128 v[192:195], v5
    ds_read_b64_tr_b16 v[196:197], v13 offset:4096
    ds_read_b64_tr_b16 v[198:199], v13 offset:4608
    ds_read_b64_tr_b16 v[200:201], v13 offset:12288
    v_mov_b64 v[112:113], v[116:117]
    v_mov_b64 v[114:115], v[118:119]
    v_mfma_f32_32x32x16_bf16 v[64:79], v[80:83], v[92:95], v[64:79]
    ds_read_b64_tr_b16 v[202:203], v13 offset:12800
    ds_read_b64_tr_b16 v[204:205], v13 offset:20480
    ds_read_b64_tr_b16 v[206:207], v13 offset:20992
    v_mov_b64 v[116:117], v[120:121]
    v_mov_b64 v[118:119], v[122:123]
    v_mfma_f32_32x32x16_bf16 v[32:47], v[84:87], v[80:83], v[32:47]
    v_mov_b64 v[120:121], v[124:125]
    v_mov_b64 v[122:123], v[126:127]
    v_mfma_f32_16x16x32_bf16 v[224:227], v[112:115], v[80:83], v[224:227]
    s_waitcnt lgkmcnt(7)
    v_mfma_f32_32x32x16_bf16 v[48:63], v[104:107], v[96:99], v[48:63]
    ds_read_b128 v[208:211], v6
    ds_read_b64_tr_b16 v[212:213], v13 offset:6144
    ds_read_b64_tr_b16 v[214:215], v13 offset:6656
    ds_read_b64_tr_b16 v[216:217], v13 offset:14336
    v_mfma_f32_32x32x16_bf16 v[64:79], v[96:99], v[108:111], v[64:79]
    ds_read_b64_tr_b16 v[218:219], v13 offset:14848
    ds_read_b64_tr_b16 v[220:221], v13 offset:22528
    ds_read_b64_tr_b16 v[222:223], v13 offset:23040
    s_add_u32 s34, s34, 24576
    s_cmp_ge_u32 s34, 163840
    s_cselect_b32 s28, 98304, 0
    s_sub_u32 s34, s34, s28
    s_sub_u32 s28, 24576, s28
    s_add_u32 s35, s35, 1
    s_cmp_eq_u32 s35, 8
    s_cselect_b32 s29, -65536, 0
    s_add_u32 s29, s29, 8192
    v_add_u32 v13, s28, v13
    v_add_u32 v3, s29, v3
    v_add_u32 v4, s29, v4
    v_add_u32 v5, s29, v5
    v_add_u32 v6, s29, v6
    v_mfma_f32_32x32x16_bf16 v[32:47], v[100:103], v[96:99], v[32:47]
    v_mfma_f32_16x16x32_bf16 v[228:231], v[112:115], v[96:99], v[228:231]
    s_waitcnt lgkmcnt(0)
    s_barrier
    v_mfma_f32_32x32x16_bf16 v[48:63], v[200:203], v[192:195], v[48:63]
    ds_read_b128 v[80:83], v3
    ds_read_b64_tr_b16 v[84:85], v13 offset:0
    ds_read_b64_tr_b16 v[86:87], v13 offset:512
    ds_read_b64_tr_b16 v[88:89], v13 offset:8192
    v_mfma_f32_32x32x16_bf16 v[64:79], v[192:195], v[204:207], v[64:79]
    ds_read_b64_tr_b16 v[90:91], v13 offset:8704
    ds_read_b64_tr_b16 v[92:93], v13 offset:16384
    ds_read_b64_tr_b16 v[94:95], v13 offset:16896
    v_mfma_f32_32x32x16_bf16 v[32:47], v[196:199], v[192:195], v[32:47]
    v_mfma_f32_16x16x32_bf16 v[232:235], v[112:115], v[192:195], v[232:235]
    v_mfma_f32_32x32x16_bf16 v[48:63], v[216:219], v[208:211], v[48:63]
    ds_read_b128 v[96:99], v4
    ds_read_b64_tr_b16 v[100:101], v13 offset:2048
    ds_read_b64_tr_b16 v[102:103], v13 offset:2560
    ds_read_b64_tr_b16 v[104:105], v13 offset:10240
    v_mfma_f32_32x32x16_bf16 v[64:79], v[208:211], v[220:223], v[64:79]
    ds_read_b64_tr_b16 v[106:107], v13 offset:10752
    ds_read_b64_tr_b16 v[108:109], v13 offset:18432
    ds_read_b64_tr_b16 v[110:111], v13 offset:18944
    v_mfma_f32_32x32x16_bf16 v[32:47], v[212:215], v[208:211], v[32:47]
    v_mfma_f32_16x16x32_bf16 v[236:239], v[112:115], v[208:211], v[236:239]
    s_waitcnt lgkmcnt(7)
    v_mfma_f32_32x32x16_bf16 v[48:63], v[88:91], v[80:83], v[48:63]
    ds_read_b128 v[192:195], v5
    ds_read_b64_tr_b16 v[196:197], v13 offset:4096
    ds_read_b64_tr_b16 v[198:199], v13 offset:4608
    ds_read_b64_tr_b16 v[200:201], v13 offset:12288
    v_mfma_f32_32x32x16_bf16 v[64:79], v[80:83], v[92:95], v[64:79]
    ds_read_b64_tr_b16 v[202:203], v13 offset:12800
    ds_read_b64_tr_b16 v[204:205], v13 offset:20480
    ds_read_b64_tr_b16 v[206:207], v13 offset:20992
    v_mfma_f32_32x32x16_bf16 v[32:47], v[84:87], v[80:83], v[32:47]
    v_mfma_f32_16x16x32_bf16 v[240:243], v[112:115], v[80:83], v[240:243]
    s_waitcnt lgkmcnt(7)
    v_mfma_f32_32x32x16_bf16 v[48:63], v[104:107], v[96:99], v[48:63]
    ds_read_b128 v[208:211], v6
    ds_read_b64_tr_b16 v[212:213], v13 offset:6144
    ds_read_b64_tr_b16 v[214:215], v13 offset:6656
    ds_read_b64_tr_b16 v[216:217], v13 offset:14336
    v_mfma_f32_32x32x16_bf16 v[64:79], v[96:99], v[108:111], v[64:79]
    ds_read_b64_tr_b16 v[218:219], v13 offset:14848
    ds_read_b64_tr_b16 v[220:221], v13 offset:22528
    ds_read_b64_tr_b16 v[222:223], v13 offset:23040
    s_add_u32 s34, s34, 24576
    s_cmp_ge_u32 s34, 163840
    s_cselect_b32 s28, 98304, 0
    s_sub_u32 s34, s34, s28
    s_sub_u32 s28, 24576, s28
    s_add_u32 s35, s35, 1
    s_cmp_eq_u32 s35, 8
    s_cselect_b32 s29, -65536, 0
    s_add_u32 s29, s29, 8192
    v_add_u32 v13, s28, v13
    v_add_u32 v3, s29, v3
    v_add_u32 v4, s29, v4
    v_add_u32 v5, s29, v5
    v_add_u32 v6, s29, v6
    v_mfma_f32_32x32x16_bf16 v[32:47], v[100:103], v[96:99], v[32:47]
    v_mfma_f32_16x16x32_bf16 v[244:247], v[112:115], v[96:99], v[244:247]
    s_waitcnt lgkmcnt(0)
    s_barrier
    v_mfma_f32_32x32x16_bf16 v[48:63], v[200:203], v[192:195], v[48:63]
    ds_read_b128 v[80:83], v3
    ds_read_b64_tr_b16 v[84:85], v13 offset:0
    ds_read_b64_tr_b16 v[86:87], v13 offset:512
    ds_read_b64_tr_b16 v[88:89], v13 offset:8192
    v_mfma_f32_32x32x16_bf16 v[64:79], v[192:195], v[204:207], v[64:79]
    ds_read_b64_tr_b16 v[90:91], v13 offset:8704
    ds_read_b64_tr_b16 v[92:93], v13 offset:16384
    ds_read_b64_tr_b16 v[94:95], v13 offset:16896
    v_mfma_f32_32x32x16_bf16 v[32:47], v[196:199], v[192:195], v[32:47]
    v_mfma_f32_16x16x32_bf16 v[248:251], v[112:115], v[192:195], v[248:251]
    v_mfma_f32_32x32x16_bf16 v[48:63], v[216:219], v[208:211], v[48:63]
    ds_read_b128 v[96:99], v4
    ds_read_b64_tr_b16 v[100:101], v13 offset:2048
    ds_read_b64_tr_b16 v[102:103], v13 offset:2560
    ds_read_b64_tr_b16 v[104:105], v13 offset:10240
    v_mfma_f32_32x32x16_bf16 v[64:79], v[208:211], v[220:223], v[64:79]
    ds_read_b64_tr_b16 v[106:107], v13 offset:10752
    ds_read_b64_tr_b16 v[108:109], v13 offset:18432
    ds_read_b64_tr_b16 v[110:111], v13 offset:18944
    buffer_load_dword v14, v19, s[8:11], 0 offen sc1
    v_mfma_f32_32x32x16_bf16 v[32:47], v[212:215], v[208:211], v[32:47]
    v_mfma_f32_16x16x32_bf16 v[252:255], v[112:115], v[208:211], v[252:255]
    s_cmp_lt_u32 s35, 8
    s_cbranch_scc1 L_cB
    s_lshl_b32 s30, s59, 17
    s_lshl_b32 s36, s58, 10
    s_add_u32 s30, s30, s36
    s_add_u32 s31, s30, 65536
    s_lshl_b32 s32, s30, 1
    s_add_u32 s32, s32, 2097152
    s_add_u32 s33, s32, 131072
    s_mov_b32 s37, 1052289595
    s_waitcnt lgkmcnt(7)
    v_mfma_f32_32x32x16_bf16 v[160:175], v[88:91], v[80:83], 0
    ds_read_b128 v[192:195], v5
    ds_read_b64_tr_b16 v[196:197], v13 offset:4096
    ds_read_b64_tr_b16 v[198:199], v13 offset:4608
    ds_read_b64_tr_b16 v[200:201], v13 offset:12288
    v_cvt_pk_bf16_f32 v48, v48, v49
    v_cvt_pk_bf16_f32 v49, v50, v51
    v_cvt_pk_bf16_f32 v50, v52, v53
    v_cvt_pk_bf16_f32 v51, v54, v55
    buffer_store_dwordx4 v[48:51], v2, s[12:15], s32 offen sc1
    v_cvt_pk_bf16_f32 v52, v56, v57
    v_cvt_pk_bf16_f32 v53, v58, v59
    v_cvt_pk_bf16_f32 v54, v60, v61
    v_mfma_f32_32x32x16_bf16 v[176:191], v[80:83], v[92:95], 0
    ds_read_b64_tr_b16 v[202:203], v13 offset:12800
    ds_read_b64_tr_b16 v[204:205], v13 offset:20480
    ds_read_b64_tr_b16 v[206:207], v13 offset:20992
    v_cvt_pk_bf16_f32 v55, v62, v63
    buffer_store_dwordx4 v[52:55], v2, s[12:15], s33 offen sc1
    v_cvt_pk_bf16_f32 v64, v64, v65
    v_cvt_pk_bf16_f32 v65, v66, v67
    v_cvt_pk_bf16_f32 v66, v68, v69
    v_cvt_pk_bf16_f32 v67, v70, v71
    buffer_store_dwordx4 v[64:67], v18, s[12:15], s32 offen offset:1024 sc1
    v_cvt_pk_bf16_f32 v68, v72, v73
    v_mfma_f32_32x32x16_bf16 v[144:159], v[84:87], v[80:83], 0
    v_cvt_pk_bf16_f32 v69, v74, v75
    v_cvt_pk_bf16_f32 v70, v76, v77
    v_cvt_pk_bf16_f32 v71, v78, v79
    buffer_store_dwordx4 v[68:71], v18, s[12:15], s32 offen offset:1536 sc1
    v_mul_f32 v32, s37, v32
    v_mul_f32 v33, s37, v33
    v_mul_f32 v34, s37, v34
    v_mul_f32 v35, s37, v35
    s_waitcnt lgkmcnt(7)
    v_mfma_f32_32x32x16_bf16 v[160:175], v[104:107], v[96:99], v[160:175]
    ds_read_b128 v[208:211], v6
    ds_read_b64_tr_b16 v[212:213], v13 offset:6144
    ds_read_b64_tr_b16 v[214:215], v13 offset:6656
    ds_read_b64_tr_b16 v[216:217], v13 offset:14336
    v_mul_f32 v36, s37, v36
    v_mul_f32 v37, s37, v37
    v_mul_f32 v38, s37, v38
    v_mul_f32 v39, s37, v39
    v_cvt_pk_bf16_f32 v32, v32, v33
    v_cvt_pk_bf16_f32 v33, v34, v35
    v_cvt_pk_bf16_f32 v34, v36, v37
    v_cvt_pk_bf16_f32 v35, v38, v39
    v_mfma_f32_32x32x16_bf16 v[176:191], v[96:99], v[108:111], v[176:191]
    ds_read_b64_tr_b16 v[218:219], v13 offset:14848
    ds_read_b64_tr_b16 v[220:221], v13 offset:22528
    ds_read_b64_tr_b16 v[222:223], v13 offset:23040
    s_add_u32 s34, s34, 24576
    s_cmp_ge_u32 s34, 163840
    s_cselect_b32 s28, 98304, 0
    s_sub_u32 s34, s34, s28
    s_sub_u32 s28, 24576, s28
    s_add_u32 s35, s35, 1
    s_cmp_eq_u32 s35, 8
    s_cselect_b32 s29, -65536, 0
    s_add_u32 s29, s29, 8192
    v_add_u32 v13, s28, v13
    v_add_u32 v3, s29, v3
    v_add_u32 v4, s29, v4
    v_add_u32 v5, s29, v5
    v_add_u32 v6, s29, v6
    buffer_store_dwordx4 v[32:35], v2, s[12:15], s30 offen sc1
    v_mul_f32 v40, s37, v40
    v_mul_f32 v41, s37, v41
    v_mul_f32 v42, s37, v42
    v_mul_f32 v43, s37, v43
    v_mul_f32 v44, s37, v44
    v_mul_f32 v45, s37, v45
    v_mul_f32 v46, s37, v46
    v_mfma_f32_32x32x16_bf16 v[144:159], v[100:103], v[96:99], v[144:159]
    v_mul_f32 v47, s37, v47
    v_cvt_pk_bf16_f32 v36, v40, v41
    v_cvt_pk_bf16_f32 v37, v42, v43
    v_cvt_pk_bf16_f32 v38, v44, v45
    v_cvt_pk_bf16_f32 v39, v46, v47
    buffer_store_dwordx4 v[36:39], v2, s[12:15], s31 offen sc1
    s_waitcnt lgkmcnt(0)
    s_barrier
    s_mov_b32 exec_lo, s46
    s_mov_b32 exec_hi, 0
    ds_write_b128 v139, v[24:27] offset:2048
    s_mov_b64 exec, -1
    v_mfma_f32_32x32x16_bf16 v[160:175], v[200:203], v[192:195], v[160:175]
    ds_read_b128 v[80:83], v3
    ds_read_b64_tr_b16 v[84:85], v13 offset:0
    ds_read_b64_tr_b16 v[86:87], v13 offset:512
    ds_read_b64_tr_b16 v[88:89], v13 offset:8192
    v_mfma_f32_32x32x16_bf16 v[176:191], v[192:195], v[204:207], v[176:191]
    ds_read_b64_tr_b16 v[90:91], v13 offset:8704
    ds_read_b64_tr_b16 v[92:93], v13 offset:16384
    ds_read_b64_tr_b16 v[94:95], v13 offset:16896
    v_mfma_f32_32x32x16_bf16 v[144:159], v[196:199], v[192:195], v[144:159]
    v_mfma_f32_32x32x16_bf16 v[160:175], v[216:219], v[208:211], v[160:175]
    ds_read_b128 v[96:99], v4
    ds_read_b64_tr_b16 v[100:101], v13 offset:2048
    ds_read_b64_tr_b16 v[102:103], v13 offset:2560
    ds_read_b64_tr_b16 v[104:105], v13 offset:10240
    v_mfma_f32_32x32x16_bf16 v[176:191], v[208:211], v[220:223], v[176:191]
    ds_read_b64_tr_b16 v[106:107], v13 offset:10752
    ds_read_b64_tr_b16 v[108:109], v13 offset:18432
    ds_read_b64_tr_b16 v[110:111], v13 offset:18944
    v_mfma_f32_32x32x16_bf16 v[144:159], v[212:215], v[208:211], v[144:159]
    s_and_b32 s60, s24, 6
    s_lshr_b32 s28, s23, 4
    s_add_u32 s60, s60, s28
    s_and_b32 s28, s23, 15
    s_lshl3_add_u32 s60, s28, s60
    s_and_b32 s28, s24, 1
    s_lshl_b32 s28, s28, 7
    s_add_u32 s60, s60, s28
    s_lshl_b32 s60, s60, 7
    s_lshl2_add_u32 s60, s20, s60
    s_add_u32 s60, s60, 15990784
    s_lshl_b32 s31, s21, 16
    s_lshl_b32 s28, s56, 10
    s_add_u32 s31, s31, s28
    s_mov_b32 s62, 0
    v_mov_b32 v16, 1
    s_waitcnt vmcnt(6)
L_ichk:
    v_cmp_ne_u32 vcc, 1, v14
    s_add_u32 s62, s62, 1
    s_cmp_gt_u32 s62, 40000
    s_cbranch_scc1 L_iok
    s_cbranch_vccz L_iok
    s_sleep 4
    buffer_load_dword v14, v19, s[8:11], 0 offen sc1
    s_waitcnt vmcnt(0)
    s_branch L_ichk
L_iok:
    s_mov_b32 s62, 0
    s_mov_b32 s63, 14
L_cA:
    s_waitcnt lgkmcnt(7)
    v_mfma_f32_32x32x16_bf16 v[160:175], v[88:91], v[80:83], v[160:175]
    ds_read_b128 v[192:195], v5
    ds_read_b64_tr_b16 v[196:197], v13 offset:4096
    ds_read_b64_tr_b16 v[198:199], v13 offset:4608
    ds_read_b64_tr_b16 v[200:201], v13 offset:12288
    v_mfma_f32_32x32x16_bf16 v[176:191], v[80:83], v[92:95], v[176:191]
    ds_read_b64_tr_b16 v[202:203], v13 offset:12800
    ds_read_b64_tr_b16 v[204:205], v13 offset:20480
    ds_read_b64_tr_b16 v[206:207], v13 offset:20992
    v_mfma_f32_32x32x16_bf16 v[144:159], v[84:87], v[80:83], v[144:159]
    s_cmp_eq_u32 s62, 0
    s_cbranch_scc1 L_sf0
L_sr0:
    s_waitcnt lgkmcnt(7)
    v_mfma_f32_32x32x16_bf16 v[160:175], v[104:107], v[96:99], v[160:175]
    ds_read_b128 v[208:211], v6
    ds_read_b64_tr_b16 v[212:213], v13 offset:6144
    ds_read_b64_tr_b16 v[214:215], v13 offset:6656
    ds_read_b64_tr_b16 v[216:217], v13 offset:14336
    v_mfma_f32_32x32x16_bf16 v[176:191], v[96:99], v[108:111], v[176:191]
    ds_read_b64_tr_b16 v[218:219], v13 offset:14848
    ds_read_b64_tr_b16 v[220:221], v13 offset:22528
    ds_read_b64_tr_b16 v[222:223], v13 offset:23040
    s_add_u32 s34, s34, 24576
    s_cmp_ge_u32 s34, 163840
    s_cselect_b32 s28, 98304, 0
    s_sub_u32 s34, s34, s28
    s_sub_u32 s28, 24576, s28
    s_add_u32 s35, s35, 1
    s_cmp_eq_u32 s35, 8
    s_cselect_b32 s29, -65536, 0
    s_add_u32 s29, s29, 8192
    v_add_u32 v13, s28, v13
    v_add_u32 v3, s29, v3
    v_add_u32 v4, s29, v4
    v_add_u32 v5, s29, v5
    v_add_u32 v6, s29, v6
    v_mfma_f32_32x32x16_bf16 v[144:159], v[100:103], v[96:99], v[144:159]
    s_cmp_ge_u32 s35, 15
    s_waitcnt lgkmcnt(0)
    s_cbranch_scc1 L_cA15
    s_barrier
L_nb15:
    v_mfma_f32_32x32x16_bf16 v[160:175], v[200:203], v[192:195], v[160:175]
    ds_read_b32 v15, v7
    ds_read_b128 v[80:83], v3
    ds_read_b64_tr_b16 v[84:85], v13 offset:0
    ds_read_b64_tr_b16 v[86:87], v13 offset:512
    v_mfma_f32_32x32x16_bf16 v[176:191], v[192:195], v[204:207], v[176:191]
    ds_read_b64_tr_b16 v[88:89], v13 offset:8192
    ds_read_b64_tr_b16 v[90:91], v13 offset:8704
    ds_read_b64_tr_b16 v[92:93], v13 offset:16384
    ds_read_b64_tr_b16 v[94:95], v13 offset:16896
    v_mfma_f32_32x32x16_bf16 v[144:159], v[196:199], v[192:195], v[144:159]
    v_mfma_f32_32x32x16_bf16 v[160:175], v[216:219], v[208:211], v[160:175]
    ds_read_b128 v[96:99], v4
    ds_read_b64_tr_b16 v[100:101], v13 offset:2048
    ds_read_b64_tr_b16 v[102:103], v13 offset:2560
    ds_read_b64_tr_b16 v[104:105], v13 offset:10240
    v_mfma_f32_32x32x16_bf16 v[176:191], v[208:211], v[220:223], v[176:191]
    ds_read_b64_tr_b16 v[106:107], v13 offset:10752
    ds_read_b64_tr_b16 v[108:109], v13 offset:18432
    ds_read_b64_tr_b16 v[110:111], v13 offset:18944
    v_mfma_f32_32x32x16_bf16 v[144:159], v[212:215], v[208:211], v[144:159]
    s_cmp_eq_u32 s62, 0
    s_cbranch_scc1 L_sf2
L_sr2:
    s_cmp_lt_u32 s35, s63
    s_cbranch_scc1 L_cA
    s_waitcnt lgkmcnt(14)
    v_readfirstlane_b32 s28, v15
    s_cmp_eq_u32 s28, 0
    s_cbranch_scc1 L_cA
    buffer_load_dwordx4 v[8:11], v2, s[12:15], s31 offen sc1
    s_mov_b32 s63, 99
    s_branch L_cA
L_sf0:
    s_getreg_b32 s28, hwreg(HW_REG_IB_STS)
    s_and_b32 s28, s28, 0xc0000f
    s_cmp_ge_u32 s35, 12
    s_cselect_b32 s28, 0, s28
    s_cmp_eq_u32 s28, 0
    s_cbranch_scc0 L_sr0
    s_waitcnt vmcnt(0)
    s_mov_b64 exec, 1
    buffer_store_dword v16, v139, s[12:15], s60 offen sc1
    s_mov_b64 exec, -1
    s_mov_b32 s62, 1
    s_branch L_sr0
L_sf2:
    s_getreg_b32 s28, hwreg(HW_REG_IB_STS)
    s_and_b32 s28, s28, 0xc0000f
    s_cmp_ge_u32 s35, 12
    s_cselect_b32 s28, 0, s28
    s_cmp_eq_u32 s28, 0
    s_cbranch_scc0 L_sr2
    s_waitcnt vmcnt(0)
    s_mov_b64 exec, 1
    buffer_store_dword v16, v139, s[12:15], s60 offen sc1
    s_mov_b64 exec, -1
    s_mov_b32 s62, 1
    s_branch L_sr2
L_cA15:
    s_cmp_eq_u32 s35, 15
    s_cbranch_scc1 L_nb15
    v_mfma_f32_32x32x16_bf16 v[160:175], v[200:203], v[192:195], v[160:175]
    ds_read_b32 v15, v7
    v_mfma_f32_32x32x16_bf16 v[176:191], v[192:195], v[204:207], v[176:191]
    v_mfma_f32_32x32x16_bf16 v[144:159], v[196:199], v[192:195], v[144:159]
    s_cmp_eq_u32 s63, 99
    s_cbranch_scc1 L_qdone
    s_waitcnt lgkmcnt(0)
    v_readfirstlane_b32 s28, v15
    s_cmp_eq_u32 s28, 0
    s_cbranch_scc1 L_qdone
    buffer_load_dwordx4 v[8:11], v2, s[12:15], s31 offen sc1
    s_mov_b32 s63, 99
L_qdone:
    v_mfma_f32_32x32x16_bf16 v[160:175], v[216:219], v[208:211], v[160:175]
    v_mfma_f32_32x32x16_bf16 v[176:191], v[208:211], v[220:223], v[176:191]
    s_mov_b32 s29, 1052289595
    v_mfma_f32_32x32x16_bf16 v[144:159], v[212:215], v[208:211], v[144:159]
    s_nop 3
    v_cvt_pk_bf16_f32 v120, v160, v161
    v_cvt_pk_bf16_f32 v121, v162, v163
    v_cvt_pk_bf16_f32 v122, v164, v165
    v_cvt_pk_bf16_f32 v123, v166, v167
    v_cvt_pk_bf16_f32 v124, v168, v169
    v_cvt_pk_bf16_f32 v125, v170, v171
    v_cvt_pk_bf16_f32 v126, v172, v173
    v_cvt_pk_bf16_f32 v127, v174, v175
    v_cvt_pk_bf16_f32 v132, v184, v185
    v_cvt_pk_bf16_f32 v133, v186, v187
    v_cvt_pk_bf16_f32 v134, v188, v189
    v_cvt_pk_bf16_f32 v135, v190, v191
    v_cvt_pk_bf16_f32 v128, v176, v177
    v_cvt_pk_bf16_f32 v129, v178, v179
    v_cvt_pk_bf16_f32 v130, v180, v181
    v_cvt_pk_bf16_f32 v131, v182, v183
    v_mul_f32 v144, s29, v144
    v_mul_f32 v145, s29, v145
    v_mul_f32 v146, s29, v146
    v_mul_f32 v147, s29, v147
    v_mul_f32 v148, s29, v148
    v_mul_f32 v149, s29, v149
    v_mul_f32 v150, s29, v150
    v_mul_f32 v151, s29, v151
    v_mul_f32 v152, s29, v152
    v_mul_f32 v153, s29, v153
    v_mul_f32 v154, s29, v154
    v_mul_f32 v155, s29, v155
    v_mul_f32 v156, s29, v156
    v_mul_f32 v157, s29, v157
    v_mul_f32 v158, s29, v158
    v_mul_f32 v159, s29, v159
    v_cvt_pk_bf16_f32 v112, v144, v145
    v_cvt_pk_bf16_f32 v113, v146, v147
    v_cvt_pk_bf16_f32 v114, v148, v149
    v_cvt_pk_bf16_f32 v115, v150, v151
    v_cvt_pk_bf16_f32 v116, v152, v153
    v_cvt_pk_bf16_f32 v117, v154, v155
    v_cvt_pk_bf16_f32 v118, v156, v157
    v_cvt_pk_bf16_f32 v119, v158, v159
    v_and_b32 v24, 31, v1
    v_lshrrev_b32 v25, 5, v1
    v_lshlrev_b32 v6, 4, v24
    v_lshl_add_u32 v6, v25, 8, v6
    v_mov_b32 v5, 2048
    v_and_b32 v26, 27, v24
    v_mov_b32 v27, 0x40000
    v_cmp_eq_u32 vcc, 16, v26
    s_mov_b32 s38, 0
    s_nop 0
    v_cndmask_b32 v5, v27, v5, vcc
    v_cmp_gt_u32 vcc, 16, v24
    v_add_u32 v3, 1024, v6
    v_add_u32 v4, 1536, v6
    v_cndmask_b32 v3, v5, v3, vcc
    v_cndmask_b32 v4, v5, v4, vcc
    v_lshrrev_b32 v24, 1, v2
    v_xor_b32 v24, v24, v2
    v_and_b32 v24, 64, v24
    v_mul_u32_u24 v24, 3, v24
    v_xor_b32 v5, v24, v2
    s_cmp_eq_u32 s63, 99
    s_cbranch_scc1 L_qok
    s_mov_b32 s29, 0
L_qspin:
    ds_read_b32 v15, v7
    s_add_u32 s29, s29, 1
    s_waitcnt lgkmcnt(0)
    v_readfirstlane_b32 s28, v15
    s_cmp_gt_u32 s29, 320000
    s_cselect_b32 s28, 1, s28
    s_cmp_eq_u32 s28, 0
    s_cbranch_scc0 L_qgo
    s_sleep 1
    s_branch L_qspin
L_qgo:
    buffer_load_dwordx4 v[8:11], v2, s[12:15], s31 offen sc1
L_qok:
    s_mov_b32 m0, s49
    s_barrier
    s_setprio 3
    buffer_load_dwordx4 v138, s[16:19], s48 offen lds
L_main:
L_P_main:
    ds_read_b128 v[24:27], v5
    ds_read_b128 v[12:15], v5 offset:2064
    ds_read_b128 v[16:19], v3
    v_mov_b32 v64, 0xdddddddd
    s_waitcnt vmcnt(1) lgkmcnt(2)
    v_mfma_f32_32x32x16_bf16 v[32:47], v[24:27], v[8:11], 0
    s_cmp_lt_u32 s20, 4
    v_mov_b64 v[80:81], 0
    v_mov_b64 v[82:83], 0
    v_mov_b64 v[84:85], 0
    v_mov_b64 v[86:87], 0
    v_mov_b64 v[88:89], 0
    v_mov_b64 v[90:91], 0
    v_mov_b64 v[92:93], 0
    v_mov_b64 v[94:95], 0
    s_nop 1
    s_waitcnt lgkmcnt(0)
    s_cbranch_scc0 L_lseg
L_T1_0:
L_P_T1:
    v_exp_f32 v32, v32
    v_exp_f32 v33, v33
    s_waitcnt lgkmcnt(1)
    ds_read_b128 v[20:23], v4 offset:0
    s_and_b32 s75, s20, 3
    s_lshr_b32 s76, s21, 2
    s_lshl_b32 s76, s76, 3
    v_exp_f32 v34, v34
    v_exp_f32 v35, v35
    v_exp_f32 v36, v36
    v_exp_f32 v37, v37
    v_mfma_f32_32x32x16_bf16 v[48:63], v[12:15], v[8:11], 0
    s_waitcnt lgkmcnt(1)
    ds_read_b128 v[12:15], v5 offset:4128
    s_and_b32 s79, s21, 3
    s_lshl_b32 s79, s79, 1
    s_add_u32 s76, s76, s79
    v_exp_f32 v38, v38
    v_exp_f32 v39, v39
    v_exp_f32 v40, v40
    v_exp_f32 v41, v41
    v_exp_f32 v42, v42
    v_smfmac_f32_32x32x32_bf16 v[80:95], v[16:19], v[32:39], v64
    s_waitcnt lgkmcnt(1)
    ds_read_b128 v[16:19], v3 offset:2064
    s_lshr_b32 s79, s20, 2
    s_add_u32 s76, s76, s79
    s_lshr_b32 s79, s75, 1
    v_exp_f32 v43, v43
    v_exp_f32 v44, v44
    v_exp_f32 v45, v45
    v_exp_f32 v46, v46
    v_exp_f32 v47, v47
L_T2_1:
L_P_T2:
    v_exp_f32 v48, v48
    v_exp_f32 v49, v49
    v_smfmac_f32_32x32x32_bf16 v[80:95], v[20:23], v[40:47], v64
    s_waitcnt lgkmcnt(1)
    ds_read_b128 v[20:23], v4 offset:2064
    s_lshl_b32 s70, s22, 1
    s_add_u32 s70, s70, s79
    s_xor_b32 s71, s70, 1
    v_exp_f32 v50, v50
    v_exp_f32 v51, v51
    v_exp_f32 v52, v52
    v_exp_f32 v53, v53
    v_mfma_f32_32x32x16_bf16 v[32:47], v[12:15], v[8:11], 0
    s_waitcnt lgkmcnt(1)
    ds_read_b128 v[12:15], v5 offset:6192
    s_lshl_b32 s77, s75, 13
    s_lshl_b32 s70, s70, 15
    s_lshl_b32 s71, s71, 15
    v_exp_f32 v54, v54
    v_exp_f32 v55, v55
    v_exp_f32 v56, v56
    v_exp_f32 v57, v57
    v_exp_f32 v58, v58
    v_smfmac_f32_32x32x32_bf16 v[80:95], v[16:19], v[48:55], v64
    s_waitcnt lgkmcnt(1)
    ds_read_b128 v[16:19], v3 offset:4128
    s_lshl_b32 s72, s76, 15
    s_add_u32 s72, s72, s77
    v_exp_f32 v59, v59
    v_exp_f32 v60, v60
    v_exp_f32 v61, v61
    v_exp_f32 v62, v62
    v_exp_f32 v63, v63
L_T3_2:
L_P_T3:
    v_exp_f32 v32, v32
    v_exp_f32 v33, v33
    v_smfmac_f32_32x32x32_bf16 v[80:95], v[20:23], v[56:63], v64
    s_waitcnt lgkmcnt(1)
    ds_read_b128 v[20:23], v4 offset:4128
    s_add_u32 s77, s77, 14680064
    s_add_u32 s70, s70, s77
    s_add_u32 s71, s71, s77
    v_exp_f32 v34, v34
    v_exp_f32 v35, v35
    v_exp_f32 v36, v36
    v_exp_f32 v37, v37
    v_mfma_f32_32x32x16_bf16 v[48:63], v[12:15], v[8:11], 0
    s_waitcnt lgkmcnt(1)
    ds_read_b128 v[12:15], v5 offset:8256
    s_and_b32 s77, s22, 6
    s_and_b32 s79, s22, 1
    s_lshl_b32 s79, s79, 7
    v_exp_f32 v38, v38
    v_exp_f32 v39, v39
    v_exp_f32 v40, v40
    v_exp_f32 v41, v41
    v_exp_f32 v42, v42
    v_smfmac_f32_32x32x32_bf16 v[80:95], v[16:19], v[32:39], v64
    s_waitcnt lgkmcnt(1)
    ds_read_b128 v[16:19], v3 offset:6192
    s_add_u32 s77, s77, s79
    s_lshl_b32 s79, s75, 5
    s_add_u32 s77, s77, s79
    v_exp_f32 v43, v43
    v_exp_f32 v44, v44
    v_exp_f32 v45, v45
    v_exp_f32 v46, v46
    v_exp_f32 v47, v47
L_T4_3:
L_P_T4:
    v_exp_f32 v48, v48
    v_exp_f32 v49, v49
    v_smfmac_f32_32x32x32_bf16 v[80:95], v[20:23], v[40:47], v64
    s_waitcnt lgkmcnt(1)
    ds_read_b128 v[20:23], v4 offset:6192
    s_add_u32 s77, s77, 124928
    s_lshl_b32 s77, s77, 7
    v_bfe_u32 v108, v1, 2, 2
    v_exp_f32 v50, v50
    v_exp_f32 v51, v51
    v_exp_f32 v52, v52
    v_exp_f32 v53, v53
    v_mfma_f32_32x32x16_bf16 v[32:47], v[12:15], v[8:11], 0
    s_waitcnt lgkmcnt(1)
    ds_read_b128 v[12:15], v5 offset:10320
    v_and_b32 v110, 3, v1
    v_bfe_u32 v109, v1, 4, 1
    v_lshl_add_u32 v141, v108, 10, s77
    v_exp_f32 v54, v54
    v_exp_f32 v55, v55
    v_exp_f32 v56, v56
    v_exp_f32 v57, v57
    v_exp_f32 v58, v58
    v_smfmac_f32_32x32x32_bf16 v[80:95], v[16:19], v[48:55], v64
    s_waitcnt lgkmcnt(1)
    ds_read_b128 v[16:19], v3 offset:8256
    v_lshl_add_u32 v141, v109, 7, v141
    s_lshl_b32 s78, s75, 1
    v_exp_f32 v59, v59
    v_exp_f32 v60, v60
    v_exp_f32 v61, v61
    v_exp_f32 v62, v62
    v_exp_f32 v63, v63
L_T5_4:
L_P_T5:
    v_exp_f32 v32, v32
    v_exp_f32 v33, v33
    v_smfmac_f32_32x32x32_bf16 v[80:95], v[20:23], v[56:63], v64
    s_waitcnt lgkmcnt(1)
    ds_read_b128 v[20:23], v4 offset:8256
    s_add_u32 s78, s78, 124928
    s_lshr_b32 s77, s76, 5
    s_add_u32 s77, s77, s78
    v_exp_f32 v34, v34
    v_exp_f32 v35, v35
    v_exp_f32 v36, v36
    v_exp_f32 v37, v37
    v_mfma_f32_32x32x16_bf16 v[48:63], v[12:15], v[8:11], 0
    s_waitcnt lgkmcnt(1)
    ds_read_b128 v[12:15], v5 offset:12384
    s_bfe_u32 s79, s76, 0x40001
    s_lshl_b32 s79, s79, 3
    s_add_u32 s77, s77, s79
    v_exp_f32 v38, v38
    v_exp_f32 v39, v39
    v_exp_f32 v40, v40
    v_exp_f32 v41, v41
    v_exp_f32 v42, v42
    v_smfmac_f32_32x32x32_bf16 v[80:95], v[16:19], v[32:39], v64
    s_waitcnt lgkmcnt(1)
    ds_read_b128 v[16:19], v3 offset:10320
    s_lshl_b32 s77, s77, 7
    s_mov_b32 exec_lo, 0
    v_lshl_add_u32 v141, v109, 14, s77
    s_mov_b32 exec_lo, -1
    v_lshl_add_u32 v141, v110, 2, v141
    v_exp_f32 v43, v43
    v_exp_f32 v44, v44
    v_exp_f32 v45, v45
    v_exp_f32 v46, v46
    v_exp_f32 v47, v47
L_T6_5:
L_P_T6:
    v_exp_f32 v48, v48
    v_exp_f32 v49, v49
    v_smfmac_f32_32x32x32_bf16 v[80:95], v[20:23], v[40:47], v64
    s_waitcnt lgkmcnt(1)
    ds_read_b128 v[20:23], v4 offset:10320
    s_lshr_b32 s77, s76, 3
    s_lshl_b32 s77, s77, 5
    s_add_u32 s77, s77, s78
    v_exp_f32 v50, v50
    v_exp_f32 v51, v51
    v_exp_f32 v52, v52
    v_exp_f32 v53, v53
    v_mfma_f32_32x32x16_bf16 v[32:47], v[12:15], v[8:11], 0
    s_waitcnt lgkmcnt(1)
    ds_read_b128 v[12:15], v5 offset:14448
    s_lshl_b32 s77, s77, 7
    s_add_u32 s77, s77, 16
    v_lshl_add_u32 v108, v109, 7, s77
    v_exp_f32 v54, v54
    v_exp_f32 v55, v55
    v_exp_f32 v56, v56
    v_exp_f32 v57, v57
    v_exp_f32 v58, v58
    v_smfmac_f32_32x32x32_bf16 v[80:95], v[16:19], v[48:55], v64
    s_waitcnt lgkmcnt(1)
    ds_read_b128 v[16:19], v3 offset:12384
    s_and_b32 s77, s26, 6
    s_and_b32 s79, s26, 1
    v_exp_f32 v59, v59
    v_exp_f32 v60, v60
    v_exp_f32 v61, v61
    v_exp_f32 v62, v62
    v_exp_f32 v63, v63
L_T7_6:
L_P_T7:
    v_exp_f32 v32, v32
    v_exp_f32 v33, v33
    v_smfmac_f32_32x32x32_bf16 v[80:95], v[20:23], v[56:63], v64
    s_waitcnt lgkmcnt(1)
    ds_read_b128 v[20:23], v4 offset:12384
    s_lshl_b32 s79, s79, 7
    s_add_u32 s77, s77, s79
    s_lshr_b32 s79, s56, 5
    v_exp_f32 v34, v34
    v_exp_f32 v35, v35
    v_exp_f32 v36, v36
    v_exp_f32 v37, v37
    v_mfma_f32_32x32x16_bf16 v[48:63], v[12:15], v[8:11], 0
    s_waitcnt lgkmcnt(1)
    ds_read_b128 v[12:15], v5 offset:16512
    s_add_u32 s77, s77, s79
    s_bfe_u32 s79, s56, 0x40001
    s_lshl_b32 s79, s79, 3
    v_exp_f32 v38, v38
    v_exp_f32 v39, v39
    v_exp_f32 v40, v40
    v_exp_f32 v41, v41
    v_exp_f32 v42, v42
    v_smfmac_f32_32x32x32_bf16 v[80:95], v[16:19], v[32:39], v64
    s_waitcnt lgkmcnt(1)
    ds_read_b128 v[16:19], v3 offset:14448
    s_add_u32 s77, s77, s79
    s_lshl_b32 s77, s77, 5
    s_and_b32 s79, s56, 1
    v_exp_f32 v43, v43
    v_exp_f32 v44, v44
    v_exp_f32 v45, v45
    v_exp_f32 v46, v46
    v_exp_f32 v47, v47
L_T8_7:
L_P_T8:
    s_setprio 2
    v_exp_f32 v48, v48
    v_exp_f32 v49, v49
    v_smfmac_f32_32x32x32_bf16 v[80:95], v[20:23], v[40:47], v64
    s_waitcnt lgkmcnt(1)
    ds_read_b128 v[20:23], v4 offset:14448
    s_add_u32 s77, s77, s79
    s_and_b32 s79, s21, 2
    s_add_u32 s77, s77, s79
    v_exp_f32 v50, v50
    v_exp_f32 v51, v51
    v_exp_f32 v52, v52
    v_exp_f32 v53, v53
    v_mfma_f32_32x32x16_bf16 v[32:47], v[12:15], v[8:11], 0
    s_waitcnt lgkmcnt(1)
    ds_read_b128 v[12:15], v5 offset:18576
    s_lshl_b32 s77, s77, 2
    s_add_u32 s77, s77, 15990784
    s_mov_b32 exec_lo, 0
    s_mov_b32 exec_hi, 0x00f000f0
    v_lshl_add_u32 v141, v110, 10, v108
    s_mov_b32 exec_hi, 0xff00ff00
    v_mov_b32 v141, s77
    s_mov_b64 exec, -1
    v_exp_f32 v54, v54
    v_exp_f32 v55, v55
    v_exp_f32 v56, v56
    v_exp_f32 v57, v57
    v_exp_f32 v58, v58
    v_smfmac_f32_32x32x32_bf16 v[80:95], v[16:19], v[48:55], v64
    s_waitcnt lgkmcnt(1)
    ds_read_b128 v[16:19], v3 offset:16512
    s_and_b32 s88, s75, 1
    s_lshl_b32 s88, s88, 8
    v_exp_f32 v59, v59
    v_exp_f32 v60, v60
    v_exp_f32 v61, v61
    v_exp_f32 v62, v62
    v_exp_f32 v63, v63
L_T9_8:
L_P_T9:
    v_add_f32_dpp v224, v224, v230 quad_perm:[0,1,2,3] row_mask:1 bank_mask:0xf
    v_add_f32_dpp v225, v225, v231 quad_perm:[0,1,2,3] row_mask:1 bank_mask:0xf
    v_add_f32_dpp v224, v232, v238 quad_perm:[0,1,2,3] row_mask:2 bank_mask:0xf
    v_add_f32_dpp v225, v233, v239 quad_perm:[0,1,2,3] row_mask:2 bank_mask:0xf
    v_add_f32_dpp v224, v240, v246 quad_perm:[0,1,2,3] row_mask:4 bank_mask:0xf
    v_add_f32_dpp v225, v241, v247 quad_perm:[0,1,2,3] row_mask:4 bank_mask:0xf
    v_add_f32_dpp v224, v248, v254 quad_perm:[0,1,2,3] row_mask:8 bank_mask:0xf
    v_add_f32_dpp v225, v249, v255 quad_perm:[0,1,2,3] row_mask:8 bank_mask:0xf
    v_and_b32 v30, 31, v1
    v_lshlrev_b32 v30, 2, v30
    v_permlane16_swap_b32 v224, v225
    s_nop 1
    v_add_f32 v224, v224, v225
    v_mov_b32 v225, v224
    s_nop 1
    v_permlane32_swap_b32 v224, v225
    s_nop 1
    v_add_f32 v224, v224, v225
    v_mul_f32 v224, 3216550459, v224
    v_exp_f32 v224, v224
    s_nop 0
    v_add_f32 v224, 1.0, v224
    v_rcp_f32 v136, v224
    s_waitcnt vmcnt(0)
    s_lshl_b32 s30, s61, 12
    s_add_u32 s30, s30, 6291456
    v_lshrrev_b32 v28, 1, v2
    s_mov_b32 exec_lo, 0xff000000
    s_mov_b32 exec_hi, 0xff000000
    buffer_store_dwordx4 v[120:123], v2, s[12:15], s30 offen sc1
    buffer_store_dwordx4 v[124:127], v2, s[12:15], s30 offen offset:1024 sc1
    s_mov_b64 exec, -1
    buffer_store_dwordx2 v[134:135], v28, s[12:15], s30 offen offset:2048 sc1
    ds_read_b64_tr_b16 v[24:25], v140
    ds_read_b64_tr_b16 v[26:27], v140 offset:512
    s_waitcnt lgkmcnt(0)
    buffer_store_dwordx4 v[24:27], v2, s[12:15], s47 offen sc1
    s_lshl_b32 s30, s59, 6
    s_add_u32 s30, s30, s58
    s_lshl_b32 s30, s30, 7
    s_add_u32 s30, s30, 15728640
    v_sub_f32 v29, 1.0, v136
    s_mov_b32 exec_hi, 0
    buffer_store_dword v29, v30, s[12:15], s30 offen sc1
    s_mov_b32 exec_hi, -1
    v_exp_f32 v32, v32
    v_exp_f32 v33, v33
    v_smfmac_f32_32x32x32_bf16 v[80:95], v[20:23], v[56:63], v64
    s_waitcnt lgkmcnt(1)
    ds_read_b128 v[20:23], v4 offset:16512
    s_cmp_lt_u32 s20, 4
    s_cselect_b32 s77, 132096, 0
    s_xor_b32 s79, s75, 1
    s_mul_i32 s79, s79, 6144
    v_exp_f32 v34, v34
    v_exp_f32 v35, v35
    v_exp_f32 v36, v36
    v_exp_f32 v37, v37
    v_mfma_f32_32x32x16_bf16 v[48:63], v[12:15], v[8:11], 0
    s_waitcnt lgkmcnt(1)
    ds_read_b128 v[12:15], v5 offset:20640
    s_add_u32 s79, s79, s77
    s_add_u32 s84, s79, 0
    s_xor_b32 s79, s75, 2
    v_exp_f32 v38, v38
    v_exp_f32 v39, v39
    v_exp_f32 v40, v40
    v_exp_f32 v41, v41
    v_exp_f32 v42, v42
    v_smfmac_f32_32x32x32_bf16 v[80:95], v[16:19], v[32:39], v64
    s_waitcnt lgkmcnt(1)
    ds_read_b128 v[16:19], v3 offset:18576
    s_mul_i32 s79, s79, 6144
    s_add_u32 s79, s79, s77
    s_add_u32 s85, s79, 2048
    v_exp_f32 v43, v43
    v_exp_f32 v44, v44
    v_exp_f32 v45, v45
    v_exp_f32 v46, v46
    v_exp_f32 v47, v47
L_T10_9:
L_P_T10:
    v_exp_f32 v48, v48
    v_exp_f32 v49, v49
    v_smfmac_f32_32x32x32_bf16 v[80:95], v[20:23], v[40:47], v64
    s_waitcnt lgkmcnt(1)
    ds_read_b128 v[20:23], v4 offset:18576
    s_xor_b32 s79, s75, 3
    s_mul_i32 s79, s79, 6144
    s_add_u32 s79, s79, s77
    v_exp_f32 v50, v50
    v_exp_f32 v51, v51
    v_exp_f32 v52, v52
    v_exp_f32 v53, v53
    v_mfma_f32_32x32x16_bf16 v[32:47], v[12:15], v[8:11], 0
    s_waitcnt lgkmcnt(1)
    ds_read_b128 v[12:15], v5 offset:22704
    s_add_u32 s86, s79, 4096
    s_mul_i32 s79, s75, 6144
    s_add_u32 s87, s79, s77
    v_exp_f32 v54, v54
    v_exp_f32 v55, v55
    v_exp_f32 v56, v56
    v_exp_f32 v57, v57
    v_exp_f32 v58, v58
    v_smfmac_f32_32x32x32_bf16 v[80:95], v[16:19], v[48:55], v64
    s_waitcnt lgkmcnt(1)
    ds_read_b128 v[16:19], v3 offset:20640
    s_lshr_b32 s77, s76, 1
    s_lshl_b32 s77, s77, 6
    v_exp_f32 v59, v59
    v_exp_f32 v60, v60
    v_exp_f32 v61, v61
    v_exp_f32 v62, v62
    v_exp_f32 v63, v63
L_T11_10:
L_P_T11:
    v_exp_f32 v32, v32
    v_exp_f32 v33, v33
    v_smfmac_f32_32x32x32_bf16 v[80:95], v[20:23], v[56:63], v64
    s_waitcnt lgkmcnt(1)
    ds_read_b128 v[20:23], v4 offset:20640
    s_and_b32 s79, s76, 1
    s_add_u32 s77, s77, s79
    s_lshl_b32 s77, s77, 10
    v_exp_f32 v34, v34
    v_exp_f32 v35, v35
    v_exp_f32 v36, v36
    v_exp_f32 v37, v37
    v_mfma_f32_32x32x16_bf16 v[48:63], v[12:15], v[8:11], 0
    s_waitcnt lgkmcnt(1)
    ds_read_b128 v[12:15], v5 offset:24768
    s_lshl_b32 s73, s22, 7
    s_add_u32 s73, s73, s77
    s_lshl_b32 s79, s75, 5
    v_exp_f32 v38, v38
    v_exp_f32 v39, v39
    v_exp_f32 v40, v40
    v_exp_f32 v41, v41
    v_exp_f32 v42, v42
    v_smfmac_f32_32x32x32_bf16 v[80:95], v[16:19], v[32:39], v64
    s_waitcnt lgkmcnt(1)
    ds_read_b128 v[16:19], v3 offset:22704
    s_add_u32 s73, s73, s79
    s_lshr_b32 s74, s21, 1
    s_lshl_b32 s74, s74, 6
    v_exp_f32 v43, v43
    v_exp_f32 v44, v44
    v_exp_f32 v45, v45
    v_exp_f32 v46, v46
    v_exp_f32 v47, v47
L_T12_11:
L_P_T12:
    s_setprio 1
    v_exp_f32 v48, v48
    v_exp_f32 v49, v49
    v_smfmac_f32_32x32x32_bf16 v[80:95], v[20:23], v[40:47], v64
    s_waitcnt lgkmcnt(1)
    ds_read_b128 v[20:23], v4 offset:22704
    s_add_u32 s74, s74, s56
    s_lshl_b32 s74, s74, 7
    s_add_u32 s74, s74, 15728640
    v_exp_f32 v50, v50
    v_exp_f32 v51, v51
    v_exp_f32 v52, v52
    v_exp_f32 v53, v53
    v_mfma_f32_32x32x16_bf16 v[32:47], v[12:15], v[8:11], 0
    s_waitcnt lgkmcnt(1)
    ds_read_b128 v[12:15], v5 offset:26832
    s_mov_b32 s80, s50
    s_mov_b32 s81, s51
    s_mov_b32 s82, 0x200000
    v_exp_f32 v54, v54
    v_exp_f32 v55, v55
    v_exp_f32 v56, v56
    v_exp_f32 v57, v57
    v_exp_f32 v58, v58
    v_smfmac_f32_32x32x32_bf16 v[80:95], v[16:19], v[48:55], v64
    s_waitcnt lgkmcnt(1)
    ds_read_b128 v[16:19], v3 offset:24768
    s_mov_b32 s83, 0x00020000
    v_xor_b32 v7, s88, v2
    v_exp_f32 v59, v59
    v_exp_f32 v60, v60
    v_exp_f32 v61, v61
    v_exp_f32 v62, v62
    v_exp_f32 v63, v63
L_T13_12:
L_P_T13:
    s_waitcnt vmcnt(0)
    s_mov_b64 exec, 1
    v_mov_b32 v28, 2
    buffer_store_dword v28, v139, s[12:15], s60 offen sc1
    s_mov_b64 exec, -1
    v_exp_f32 v32, v32
    v_exp_f32 v33, v33
    v_smfmac_f32_32x32x32_bf16 v[80:95], v[20:23], v[56:63], v64
    s_waitcnt lgkmcnt(1)
    ds_read_b128 v[20:23], v4 offset:24768
    v_exp_f32 v34, v34
    v_exp_f32 v35, v35
    v_exp_f32 v36, v36
    v_exp_f32 v37, v37
    v_mfma_f32_32x32x16_bf16 v[48:63], v[12:15], v[8:11], 0
    s_waitcnt lgkmcnt(1)
    ds_read_b128 v[12:15], v5 offset:28896
    v_exp_f32 v38, v38
    v_exp_f32 v39, v39
    v_exp_f32 v40, v40
    v_exp_f32 v41, v41
    v_exp_f32 v42, v42
    v_smfmac_f32_32x32x32_bf16 v[80:95], v[16:19], v[32:39], v64
    s_waitcnt lgkmcnt(1)
    ds_read_b128 v[16:19], v3 offset:26832
    v_exp_f32 v43, v43
    v_exp_f32 v44, v44
    v_exp_f32 v45, v45
    v_exp_f32 v46, v46
    v_exp_f32 v47, v47
L_T14_13:
L_P_T14:
    s_setprio 0
    v_exp_f32 v48, v48
    v_exp_f32 v49, v49
    v_smfmac_f32_32x32x32_bf16 v[80:95], v[20:23], v[40:47], v64
    s_waitcnt lgkmcnt(1)
    ds_read_b128 v[20:23], v4 offset:26832
    v_exp_f32 v50, v50
    v_exp_f32 v51, v51
    v_exp_f32 v52, v52
    v_exp_f32 v53, v53
    v_mfma_f32_32x32x16_bf16 v[32:47], v[12:15], v[8:11], 0
    s_waitcnt lgkmcnt(1)
    ds_read_b128 v[12:15], v5 offset:30960
    v_exp_f32 v54, v54
    v_exp_f32 v55, v55
    v_exp_f32 v56, v56
    v_exp_f32 v57, v57
    v_exp_f32 v58, v58
    v_smfmac_f32_32x32x32_bf16 v[80:95], v[16:19], v[48:55], v64
    s_waitcnt lgkmcnt(1)
    ds_read_b128 v[16:19], v3 offset:28896
    v_exp_f32 v59, v59
    v_exp_f32 v60, v60
    v_exp_f32 v61, v61
    v_exp_f32 v62, v62
    v_exp_f32 v63, v63
L_T15_14:
L_P_T15:
    s_barrier
    s_cmp_eq_u32 s20, 0
    s_cbranch_scc0 L_G1c
    s_lshl_b32 s28, s2, 7
    s_add_u32 s28, s28, 15990784
    s_mov_b64 exec, 1
    v_mov_b32 v25, 3
    buffer_store_dword v25, v139, s[12:15], s28 offen offset:16 sc1
    s_mov_b64 exec, -1
L_G1c:
    s_setprio 3
    v_exp_f32 v32, v32
    v_exp_f32 v33, v33
    v_smfmac_f32_32x32x32_bf16 v[80:95], v[20:23], v[56:63], v64
    s_waitcnt lgkmcnt(1)
    ds_read_b128 v[20:23], v4 offset:28896
    v_mov_b32 v152, 4048155338
    s_movk_i32 s90, 0xff
    s_movk_i32 s91, 0xff0
    v_exp_f32 v34, v34
    v_exp_f32 v35, v35
    v_exp_f32 v36, v36
    v_exp_f32 v37, v37
    v_mfma_f32_32x32x16_bf16 v[48:63], v[12:15], v[8:11], 0
    s_waitcnt lgkmcnt(1)
    ds_read_b128 v[12:15], v5 offset:33024
    s_lshl_b64 s[92:93], s[90:91], 0
    v_cndmask_b32_e64 v160, v152, 0, s[92:93]
    v_exp_f32 v38, v38
    v_exp_f32 v39, v39
    v_exp_f32 v40, v40
    v_exp_f32 v41, v41
    v_exp_f32 v42, v42
    v_smfmac_f32_32x32x32_bf16 v[80:95], v[16:19], v[32:39], v64
    s_waitcnt lgkmcnt(1)
    ds_read_b128 v[16:19], v3 offset:30960
    s_lshl_b64 s[92:93], s[90:91], 1
    v_cndmask_b32_e64 v161, v152, 0, s[92:93]
    v_exp_f32 v43, v43
    v_exp_f32 v44, v44
    v_exp_f32 v45, v45
    v_exp_f32 v46, v46
    v_exp_f32 v47, v47
L_T16_15:
L_P_T16:
    v_exp_f32 v48, v48
    v_exp_f32 v49, v49
    v_smfmac_f32_32x32x32_bf16 v[80:95], v[20:23], v[40:47], v64
    s_waitcnt lgkmcnt(1)
    ds_read_b128 v[20:23], v4 offset:30960
    s_lshl_b64 s[92:93], s[90:91], 2
    v_cndmask_b32_e64 v162, v152, 0, s[92:93]
    v_exp_f32 v50, v50
    v_exp_f32 v51, v51
    v_exp_f32 v52, v52
    v_exp_f32 v53, v53
    v_mfma_f32_32x32x16_bf16 v[32:47], v[12:15], v[8:11], 0
    s_waitcnt lgkmcnt(1)
    ds_read_b128 v[12:15], v5 offset:35088
    s_lshl_b64 s[92:93], s[90:91], 3
    v_cndmask_b32_e64 v163, v152, 0, s[92:93]
    v_exp_f32 v54, v54
    v_exp_f32 v55, v55
    v_exp_f32 v56, v56
    v_exp_f32 v57, v57
    v_exp_f32 v58, v58
    v_smfmac_f32_32x32x32_bf16 v[80:95], v[16:19], v[48:55], v64
    s_waitcnt lgkmcnt(1)
    ds_read_b128 v[16:19], v3 offset:33024
    s_lshl_b64 s[92:93], s[90:91], 8
    v_cndmask_b32_e64 v164, v152, 0, s[92:93]
    v_exp_f32 v59, v59
    v_exp_f32 v60, v60
    v_exp_f32 v61, v61
    v_exp_f32 v62, v62
    v_exp_f32 v63, v63
L_T17_16:
L_P_T17:
    v_exp_f32 v32, v32
    v_exp_f32 v33, v33
    v_smfmac_f32_32x32x32_bf16 v[80:95], v[20:23], v[56:63], v64
    s_waitcnt lgkmcnt(1)
    ds_read_b128 v[20:23], v4 offset:33024
    s_lshl_b64 s[92:93], s[90:91], 9
    v_cndmask_b32_e64 v165, v152, 0, s[92:93]
    v_exp_f32 v34, v34
    v_exp_f32 v35, v35
    v_exp_f32 v36, v36
    v_exp_f32 v37, v37
    v_mfma_f32_32x32x16_bf16 v[48:63], v[12:15], v[8:11], 0
    s_waitcnt lgkmcnt(1)
    ds_read_b128 v[12:15], v5 offset:37152
    s_lshl_b64 s[92:93], s[90:91], 10
    v_cndmask_b32_e64 v166, v152, 0, s[92:93]
    v_exp_f32 v38, v38
    v_exp_f32 v39, v39
    v_exp_f32 v40, v40
    v_exp_f32 v41, v41
    v_exp_f32 v42, v42
    v_smfmac_f32_32x32x32_bf16 v[80:95], v[16:19], v[32:39], v64
    s_waitcnt lgkmcnt(1)
    ds_read_b128 v[16:19], v3 offset:35088
    s_lshl_b64 s[92:93], s[90:91], 11
    v_cndmask_b32_e64 v167, v152, 0, s[92:93]
    v_exp_f32 v43, v43
    v_exp_f32 v44, v44
    v_exp_f32 v45, v45
    v_exp_f32 v46, v46
    v_exp_f32 v47, v47
L_T18_17:
L_P_T18:
    s_setprio 2
    v_exp_f32 v48, v48
    v_exp_f32 v49, v49
    v_smfmac_f32_32x32x32_bf16 v[80:95], v[20:23], v[40:47], v64
    s_waitcnt lgkmcnt(1)
    ds_read_b128 v[20:23], v4 offset:35088
    v_exp_f32 v50, v50
    v_exp_f32 v51, v51
    v_exp_f32 v52, v52
    v_exp_f32 v53, v53
    v_mfma_f32_32x32x16_bf16 v[32:47], v[12:15], v[8:11], 0
    s_waitcnt lgkmcnt(1)
    ds_read_b128 v[12:15], v5 offset:39216
    s_lshl_b64 s[92:93], s[90:91], 16
    v_cndmask_b32_e64 v168, v152, 0, s[92:93]
    v_exp_f32 v54, v54
    v_exp_f32 v55, v55
    v_exp_f32 v56, v56
    v_exp_f32 v57, v57
    v_exp_f32 v58, v58
    v_smfmac_f32_32x32x32_bf16 v[80:95], v[16:19], v[48:55], v64
    s_waitcnt lgkmcnt(1)
    ds_read_b128 v[16:19], v3 offset:37152
    s_lshl_b64 s[92:93], s[90:91], 17
    v_cndmask_b32_e64 v169, v152, 0, s[92:93]
    v_exp_f32 v59, v59
    v_exp_f32 v60, v60
    v_exp_f32 v61, v61
    v_exp_f32 v62, v62
    v_exp_f32 v63, v63
L_T19_18:
L_P_T19:
    v_exp_f32 v32, v32
    v_exp_f32 v33, v33
    v_smfmac_f32_32x32x32_bf16 v[80:95], v[20:23], v[56:63], v64
    s_waitcnt lgkmcnt(1)
    ds_read_b128 v[20:23], v4 offset:37152
    s_lshl_b64 s[92:93], s[90:91], 18
    v_cndmask_b32_e64 v170, v152, 0, s[92:93]
    v_exp_f32 v34, v34
    v_exp_f32 v35, v35
    v_exp_f32 v36, v36
    v_exp_f32 v37, v37
    v_mfma_f32_32x32x16_bf16 v[48:63], v[12:15], v[8:11], 0
    s_waitcnt lgkmcnt(1)
    ds_read_b128 v[12:15], v5 offset:41280
    s_lshl_b64 s[92:93], s[90:91], 19
    v_cndmask_b32_e64 v171, v152, 0, s[92:93]
    v_exp_f32 v38, v38
    v_exp_f32 v39, v39
    v_exp_f32 v40, v40
    v_exp_f32 v41, v41
    v_exp_f32 v42, v42
    v_smfmac_f32_32x32x32_bf16 v[80:95], v[16:19], v[32:39], v64
    s_waitcnt lgkmcnt(1)
    ds_read_b128 v[16:19], v3 offset:39216
    s_lshl_b64 s[92:93], s[90:91], 24
    v_cndmask_b32_e64 v172, v152, 0, s[92:93]
    v_exp_f32 v43, v43
    v_exp_f32 v44, v44
    v_exp_f32 v45, v45
    v_exp_f32 v46, v46
    v_exp_f32 v47, v47
L_T20_19:
L_P_T20:
    v_exp_f32 v48, v48
    v_exp_f32 v49, v49
    v_smfmac_f32_32x32x32_bf16 v[80:95], v[20:23], v[40:47], v64
    s_waitcnt lgkmcnt(1)
    ds_read_b128 v[20:23], v4 offset:39216
    s_lshl_b64 s[92:93], s[90:91], 25
    s_mov_b32 s93, 3758096384
    v_cndmask_b32_e64 v173, v152, 0, s[92:93]
    v_exp_f32 v50, v50
    v_exp_f32 v51, v51
    v_exp_f32 v52, v52
    v_exp_f32 v53, v53
    v_mfma_f32_32x32x16_bf16 v[32:47], v[12:15], v[8:11], 0
    s_waitcnt lgkmcnt(1)
    ds_read_b128 v[12:15], v5 offset:43344
    s_lshl_b64 s[92:93], s[90:91], 26
    s_mov_b32 s93, 3221225472
    v_cndmask_b32_e64 v174, v152, 0, s[92:93]
    v_exp_f32 v54, v54
    v_exp_f32 v55, v55
    v_exp_f32 v56, v56
    v_exp_f32 v57, v57
    v_exp_f32 v58, v58
    v_smfmac_f32_32x32x32_bf16 v[80:95], v[16:19], v[48:55], v64
    s_waitcnt lgkmcnt(1)
    ds_read_b128 v[16:19], v3 offset:41280
    s_lshl_b64 s[92:93], s[90:91], 27
    s_mov_b32 s93, 2147483648
    v_cndmask_b32_e64 v175, v152, 0, s[92:93]
    v_exp_f32 v59, v59
    v_exp_f32 v60, v60
    v_exp_f32 v61, v61
    v_exp_f32 v62, v62
    v_exp_f32 v63, v63
L_T21_20:
L_P_T21:
    s_and_b32 s30, s23, 15
    s_cmp_eq_u32 s30, 0
    s_cselect_b32 s30, 16256, 0
    s_cmp_eq_u32 s23, 0
    s_cselect_b32 s30, 1024, s30
    s_add_u32 s30, s30, s60
    s_sub_u32 s46, s30, 1024
    buffer_load_dword v24, v139, s[12:15], s46 offen sc1
    v_exp_f32 v32, v32
    v_exp_f32 v33, v33
    v_smfmac_f32_32x32x32_bf16 v[80:95], v[20:23], v[56:63], v64
    s_waitcnt lgkmcnt(1)
    ds_read_b128 v[20:23], v4 offset:41280
    s_cmp_eq_u32 s23, 0
    s_cselect_b32 s92, 0, 0
    s_cselect_b32 s93, 0, 15
    v_cndmask_b32_e64 v188, v152, 0, s[92:93]
    v_exp_f32 v34, v34
    v_exp_f32 v35, v35
    v_exp_f32 v36, v36
    v_exp_f32 v37, v37
    v_mfma_f32_32x32x16_bf16 v[48:63], v[12:15], v[8:11], 0
    s_waitcnt lgkmcnt(1)
    ds_read_b128 v[12:15], v5 offset:45408
    v_exp_f32 v38, v38
    v_exp_f32 v39, v39
    v_exp_f32 v40, v40
    v_exp_f32 v41, v41
    v_exp_f32 v42, v42
    v_smfmac_f32_32x32x32_bf16 v[80:95], v[16:19], v[32:39], v64
    s_waitcnt lgkmcnt(1)
    ds_read_b128 v[16:19], v3 offset:43344
    s_cmp_eq_u32 s23, 0
    s_cselect_b32 s92, 0, 1
    s_cselect_b32 s93, 0, 31
    v_cndmask_b32_e64 v189, v152, 0, s[92:93]
    v_exp_f32 v43, v43
    v_exp_f32 v44, v44
    v_exp_f32 v45, v45
    v_exp_f32 v46, v46
    v_exp_f32 v47, v47
L_T22_21:
L_P_T22:
    s_setprio 1
    v_exp_f32 v48, v48
    v_exp_f32 v49, v49
    v_smfmac_f32_32x32x32_bf16 v[80:95], v[20:23], v[40:47], v64
    s_waitcnt lgkmcnt(1)
    ds_read_b128 v[20:23], v4 offset:43344
    s_cmp_eq_u32 s23, 0
    s_cselect_b32 s92, 0, 3
    s_cselect_b32 s93, 0, 63
    v_cndmask_b32_e64 v190, v152, 0, s[92:93]
    v_exp_f32 v50, v50
    v_exp_f32 v51, v51
    v_exp_f32 v52, v52
    v_exp_f32 v53, v53
    v_mfma_f32_32x32x16_bf16 v[32:47], v[12:15], v[8:11], 0
    s_waitcnt lgkmcnt(1)
    ds_read_b128 v[12:15], v5 offset:47472
    s_cmp_eq_u32 s23, 0
    s_cselect_b32 s92, 0, 7
    s_cselect_b32 s93, 0, 127
    v_cndmask_b32_e64 v191, v152, 0, s[92:93]
    v_exp_f32 v54, v54
    v_exp_f32 v55, v55
    v_exp_f32 v56, v56
    v_exp_f32 v57, v57
    v_exp_f32 v58, v58
    v_smfmac_f32_32x32x32_bf16 v[80:95], v[16:19], v[48:55], v64
    s_waitcnt lgkmcnt(1)
    ds_read_b128 v[16:19], v3 offset:45408
    v_mov_b32 v152, 0x3f803f80
    v_exp_f32 v59, v59
    v_exp_f32 v60, v60
    v_exp_f32 v61, v61
    v_exp_f32 v62, v62
    v_exp_f32 v63, v63
L_T23_22:
L_P_T23:
    v_exp_f32 v32, v32
    v_exp_f32 v33, v33
    v_smfmac_f32_32x32x32_bf16 v[80:95], v[20:23], v[56:63], v64
    s_waitcnt lgkmcnt(1)
    ds_read_b128 v[20:23], v4 offset:45408
    v_mov_b32 v153, 0x3f803f80
    v_exp_f32 v34, v34
    v_exp_f32 v35, v35
    v_exp_f32 v36, v36
    v_exp_f32 v37, v37
    v_mfma_f32_32x32x16_bf16 v[48:63], v[12:15], v[8:11], 0
    s_waitcnt lgkmcnt(1)
    ds_read_b128 v[12:15], v5 offset:49536
    v_mov_b32 v154, 0x3f803f80
    v_exp_f32 v38, v38
    v_exp_f32 v39, v39
    v_exp_f32 v40, v40
    v_exp_f32 v41, v41
    v_exp_f32 v42, v42
    v_smfmac_f32_32x32x32_bf16 v[80:95], v[16:19], v[32:39], v64
    s_waitcnt lgkmcnt(1)
    ds_read_b128 v[16:19], v3 offset:47472
    v_mov_b32 v155, 0x3f803f80
    v_exp_f32 v43, v43
    v_exp_f32 v44, v44
    v_exp_f32 v45, v45
    v_exp_f32 v46, v46
    v_exp_f32 v47, v47
L_T24_23:
L_P_T24:
    s_setprio 0
    v_exp_f32 v48, v48
    v_exp_f32 v49, v49
    v_smfmac_f32_32x32x32_bf16 v[80:95], v[20:23], v[40:47], v64
    s_waitcnt lgkmcnt(1)
    ds_read_b128 v[20:23], v4 offset:47472
    v_mov_b64 v[156:157], 0
    v_exp_f32 v50, v50
    v_exp_f32 v51, v51
    v_exp_f32 v52, v52
    v_exp_f32 v53, v53
    v_mfma_f32_32x32x16_bf16 v[32:47], v[12:15], v[8:11], 0
    s_waitcnt lgkmcnt(1)
    ds_read_b128 v[12:15], v5 offset:51600
    v_mov_b64 v[104:105], 0
    v_exp_f32 v54, v54
    v_exp_f32 v55, v55
    v_exp_f32 v56, v56
    v_exp_f32 v57, v57
    v_exp_f32 v58, v58
    v_smfmac_f32_32x32x32_bf16 v[80:95], v[16:19], v[48:55], v64
    s_waitcnt lgkmcnt(1)
    ds_read_b128 v[16:19], v3 offset:49536
    v_exp_f32 v59, v59
    v_exp_f32 v60, v60
    v_exp_f32 v61, v61
    v_exp_f32 v62, v62
    v_exp_f32 v63, v63
    v_add_u32 v5, 49536, v5
    v_add_u32 v3, 49536, v3
    v_add_u32 v4, 49536, v4
L_T25_24:
L_P_T25:
    s_barrier
    s_cmp_eq_u32 s23, 0
    s_cbranch_scc1 L_A_nohalo
    s_waitcnt vmcnt(0)
    v_readfirstlane_b32 s28, v24
    s_cmp_ge_u32 s28, 2
    s_cbranch_scc0 L_A_poll
L_A_go:
    s_sub_u32 s30, s61, 32
    s_lshl_b32 s30, s30, 12
    s_add_u32 s30, s30, 6291456
    buffer_load_dwordx4 v[96:99], v2, s[12:15], s30 offen sc1
    buffer_load_dwordx4 v[100:103], v2, s[12:15], s30 offen offset:1024 sc1
    v_lshrrev_b32 v28, 1, v2
    buffer_load_dwordx2 v[106:107], v28, s[12:15], s30 offen offset:2048 sc1
L_A_hret:
    s_setprio 3
    v_exp_f32 v32, v32
    v_exp_f32 v33, v33
    v_smfmac_f32_32x32x32_bf16 v[80:95], v[20:23], v[56:63], v64
    s_waitcnt lgkmcnt(1)
    ds_read_b128 v[20:23], v4 offset:0
    v_exp_f32 v34, v34
    v_exp_f32 v35, v35
    v_exp_f32 v36, v36
    v_exp_f32 v37, v37
    v_mfma_f32_32x32x16_bf16 v[48:63], v[12:15], v[8:11], 0
    s_waitcnt lgkmcnt(1)
    ds_read_b128 v[12:15], v5 offset:4128
    v_exp_f32 v38, v38
    v_exp_f32 v39, v39
    v_exp_f32 v40, v40
    v_exp_f32 v41, v41
    v_exp_f32 v42, v42
    v_smfmac_f32_32x32x32_bf16 v[80:95], v[16:19], v[32:39], v64
    s_waitcnt lgkmcnt(1)
    ds_read_b128 v[16:19], v3 offset:2064
    v_exp_f32 v43, v43
    v_exp_f32 v44, v44
    v_exp_f32 v45, v45
    v_exp_f32 v46, v46
    v_exp_f32 v47, v47
L_T26_25:
L_P_T26:
    v_exp_f32 v48, v48
    v_exp_f32 v49, v49
    v_smfmac_f32_32x32x32_bf16 v[80:95], v[20:23], v[40:47], v64
    s_waitcnt lgkmcnt(1)
    ds_read_b128 v[20:23], v4 offset:2064
    v_exp_f32 v50, v50
    v_exp_f32 v51, v51
    v_exp_f32 v52, v52
    v_exp_f32 v53, v53
    v_mfma_f32_32x32x16_bf16 v[32:47], v[12:15], v[8:11], 0
    s_waitcnt lgkmcnt(1)
    ds_read_b128 v[12:15], v5 offset:6192
    v_exp_f32 v54, v54
    v_exp_f32 v55, v55
    v_exp_f32 v56, v56
    v_exp_f32 v57, v57
    v_exp_f32 v58, v58
    v_smfmac_f32_32x32x32_bf16 v[80:95], v[16:19], v[48:55], v64
    s_waitcnt lgkmcnt(1)
    ds_read_b128 v[16:19], v3 offset:4128
    v_exp_f32 v59, v59
    v_exp_f32 v60, v60
    v_exp_f32 v61, v61
    v_exp_f32 v62, v62
    v_exp_f32 v63, v63
L_T27_26:
L_P_T27:
    v_exp_f32 v32, v32
    v_exp_f32 v33, v33
    v_smfmac_f32_32x32x32_bf16 v[80:95], v[20:23], v[56:63], v64
    s_waitcnt lgkmcnt(1)
    ds_read_b128 v[20:23], v4 offset:4128
    v_exp_f32 v34, v34
    v_exp_f32 v35, v35
    v_exp_f32 v36, v36
    v_exp_f32 v37, v37
    v_mfma_f32_32x32x16_bf16 v[48:63], v[12:15], v[8:11], 0
    s_waitcnt lgkmcnt(1)
    ds_read_b128 v[12:15], v5 offset:8256
    v_exp_f32 v38, v38
    v_exp_f32 v39, v39
    v_exp_f32 v40, v40
    v_exp_f32 v41, v41
    v_exp_f32 v42, v42
    v_smfmac_f32_32x32x32_bf16 v[80:95], v[16:19], v[32:39], v64
    s_waitcnt lgkmcnt(1)
    ds_read_b128 v[16:19], v3 offset:6192
    v_exp_f32 v43, v43
    v_exp_f32 v44, v44
    v_exp_f32 v45, v45
    v_exp_f32 v46, v46
    v_exp_f32 v47, v47
L_T28_27:
L_P_T28:
    v_exp_f32 v48, v48
    v_exp_f32 v49, v49
    v_smfmac_f32_32x32x32_bf16 v[80:95], v[20:23], v[40:47], v64
    s_waitcnt lgkmcnt(1)
    ds_read_b128 v[20:23], v4 offset:6192
    v_exp_f32 v50, v50
    v_exp_f32 v51, v51
    v_exp_f32 v52, v52
    v_exp_f32 v53, v53
    v_mfma_f32_32x32x16_bf16 v[32:47], v[12:15], v[8:11], 0
    s_waitcnt lgkmcnt(1)
    ds_read_b128 v[12:15], v5 offset:10320
    v_exp_f32 v54, v54
    v_exp_f32 v55, v55
    v_exp_f32 v56, v56
    v_exp_f32 v57, v57
    v_exp_f32 v58, v58
    v_smfmac_f32_32x32x32_bf16 v[80:95], v[16:19], v[48:55], v64
    s_waitcnt lgkmcnt(1)
    ds_read_b128 v[16:19], v3 offset:8256
    v_exp_f32 v59, v59
    v_exp_f32 v60, v60
    v_exp_f32 v61, v61
    v_exp_f32 v62, v62
    v_exp_f32 v63, v63
L_T29_28:
L_P_T29:
    s_lshl_b32 s30, s58, 15
    s_lshl_b32 s28, s59, 11
    s_add_u32 s30, s30, s28
    s_add_u32 s30, s30, 10485760
    s_mov_b32 s31, 1736441856
    s_waitcnt vmcnt(0)
    v_mfma_f32_32x32x16_bf16 v[192:207], v[120:123], v[112:115], v[160:175]
    v_mfma_f32_32x32x16_bf16 v[208:223], v[96:99], v[112:115], v[176:191]
    s_nop 7
    s_nop 2
    v_exp_f32 v192, v192
    v_exp_f32 v193, v193
    v_exp_f32 v194, v194
    v_exp_f32 v195, v195
    v_exp_f32 v196, v196
    v_exp_f32 v197, v197
    v_exp_f32 v198, v198
    v_exp_f32 v199, v199
    v_exp_f32 v200, v200
    v_exp_f32 v201, v201
    v_exp_f32 v202, v202
    v_exp_f32 v203, v203
    v_exp_f32 v204, v204
    v_exp_f32 v205, v205
    v_exp_f32 v206, v206
    v_exp_f32 v207, v207
    v_exp_f32 v220, v220
    v_exp_f32 v221, v221
    v_exp_f32 v222, v222
    v_exp_f32 v223, v223
    v_cvt_pk_bf16_f32 v158, v220, v221
    v_cvt_pk_bf16_f32 v192, v192, v193
    v_cvt_pk_bf16_f32 v193, v194, v195
    v_cvt_pk_bf16_f32 v194, v196, v197
    v_cvt_pk_bf16_f32 v195, v198, v199
    v_cvt_pk_bf16_f32 v196, v200, v201
    v_cvt_pk_bf16_f32 v197, v202, v203
    v_cvt_pk_bf16_f32 v198, v204, v205
    v_cvt_pk_bf16_f32 v199, v206, v207
    v_cvt_pk_bf16_f32 v159, v222, v223
    s_nop 0
    v_mfma_f32_32x32x16_bf16 v[240:255], v[152:155], v[192:195], 0
    v_mfma_f32_32x32x16_bf16 v[224:239], v[128:131], v[192:195], 0
    v_mfma_f32_32x32x16_bf16 v[240:255], v[152:155], v[196:199], v[240:255]
    v_mfma_f32_32x32x16_bf16 v[224:239], v[132:135], v[196:199], v[224:239]
    v_mfma_f32_32x32x16_bf16 v[240:255], v[152:155], v[156:159], v[240:255]
    v_mfma_f32_32x32x16_bf16 v[224:239], v[104:107], v[156:159], v[224:239]
    s_nop 7
    s_nop 2
    v_rcp_f32 v26, v240
    s_nop 0
    v_add_f32 v27, v26, v240
    v_cmp_nlt_f32 vcc, v27, s31
    s_nop 1
    s_cbranch_vccnz L_atx0
L_atr0:
    v_mul_f32 v26, v26, v136
    v_mul_f32 v224, v224, v26
    v_mul_f32 v225, v225, v26
    v_mul_f32 v226, v226, v26
    v_mul_f32 v227, v227, v26
    v_mul_f32 v228, v228, v26
    v_mul_f32 v229, v229, v26
    v_mul_f32 v230, v230, v26
    v_mul_f32 v231, v231, v26
    v_cvt_pk_bf16_f32 v28, v224, v225
    v_cvt_pk_bf16_f32 v29, v226, v227
    v_cvt_pk_bf16_f32 v30, v228, v229
    v_cvt_pk_bf16_f32 v31, v230, v231
    buffer_store_dwordx4 v[28:31], v2, s[12:15], s30 offen offset:0 sc1
    v_mfma_f32_32x32x16_bf16 v[192:207], v[124:127], v[116:119], v[160:175]
    v_mfma_f32_32x32x16_bf16 v[208:223], v[100:103], v[116:119], v[176:191]
    s_nop 7
    s_nop 2
    v_exp_f32 v192, v192
    v_exp_f32 v193, v193
    v_exp_f32 v194, v194
    v_exp_f32 v195, v195
    v_exp_f32 v196, v196
    v_exp_f32 v197, v197
    v_exp_f32 v198, v198
    v_exp_f32 v199, v199
    v_exp_f32 v200, v200
    v_exp_f32 v201, v201
    v_exp_f32 v202, v202
    v_exp_f32 v203, v203
    v_exp_f32 v204, v204
    v_exp_f32 v205, v205
    v_exp_f32 v206, v206
    v_exp_f32 v207, v207
    v_exp_f32 v220, v220
    v_exp_f32 v221, v221
    v_exp_f32 v222, v222
    v_exp_f32 v223, v223
    v_cvt_pk_bf16_f32 v158, v220, v221
    v_cvt_pk_bf16_f32 v192, v192, v193
    v_cvt_pk_bf16_f32 v193, v194, v195
    v_cvt_pk_bf16_f32 v194, v196, v197
    v_cvt_pk_bf16_f32 v195, v198, v199
    v_cvt_pk_bf16_f32 v196, v200, v201
    v_cvt_pk_bf16_f32 v197, v202, v203
    v_cvt_pk_bf16_f32 v198, v204, v205
    v_cvt_pk_bf16_f32 v199, v206, v207
    v_cvt_pk_bf16_f32 v159, v222, v223
    s_nop 0
    v_mfma_f32_32x32x16_bf16 v[240:255], v[152:155], v[192:195], 0
    v_mfma_f32_32x32x16_bf16 v[224:239], v[128:131], v[192:195], 0
    v_mfma_f32_32x32x16_bf16 v[240:255], v[152:155], v[196:199], v[240:255]
    v_mfma_f32_32x32x16_bf16 v[224:239], v[132:135], v[196:199], v[224:239]
    v_mfma_f32_32x32x16_bf16 v[240:255], v[152:155], v[156:159], v[240:255]
    v_mfma_f32_32x32x16_bf16 v[224:239], v[104:107], v[156:159], v[224:239]
    s_nop 7
    s_nop 2
    v_rcp_f32 v26, v240
    s_nop 0
    v_add_f32 v27, v26, v240
    v_cmp_nlt_f32 vcc, v27, s31
    s_nop 1
    s_cbranch_vccnz L_atx1
L_atr1:
    v_mul_f32 v26, v26, v136
    v_mul_f32 v232, v232, v26
    v_mul_f32 v233, v233, v26
    v_mul_f32 v234, v234, v26
    v_mul_f32 v235, v235, v26
    v_mul_f32 v236, v236, v26
    v_mul_f32 v237, v237, v26
    v_mul_f32 v238, v238, v26
    v_mul_f32 v239, v239, v26
    v_cvt_pk_bf16_f32 v28, v232, v233
    v_cvt_pk_bf16_f32 v29, v234, v235
    v_cvt_pk_bf16_f32 v30, v236, v237
    v_cvt_pk_bf16_f32 v31, v238, v239
    buffer_store_dwordx4 v[28:31], v2, s[12:15], s30 offen offset:1024 sc1
    v_exp_f32 v32, v32
    v_exp_f32 v33, v33
    v_smfmac_f32_32x32x32_bf16 v[80:95], v[20:23], v[56:63], v64
    s_waitcnt lgkmcnt(1)
    ds_read_b128 v[20:23], v4 offset:8256
    v_exp_f32 v34, v34
    v_exp_f32 v35, v35
    v_exp_f32 v36, v36
    v_exp_f32 v37, v37
    v_mfma_f32_32x32x16_bf16 v[48:63], v[12:15], v[8:11], 0
    s_waitcnt lgkmcnt(1)
    ds_read_b128 v[12:15], v5 offset:12384
    v_exp_f32 v38, v38
    v_exp_f32 v39, v39
    v_exp_f32 v40, v40
    v_exp_f32 v41, v41
    v_exp_f32 v42, v42
    v_smfmac_f32_32x32x32_bf16 v[80:95], v[16:19], v[32:39], v64
    s_waitcnt lgkmcnt(1)
    ds_read_b128 v[16:19], v3 offset:10320
    v_exp_f32 v43, v43
    v_exp_f32 v44, v44
    v_exp_f32 v45, v45
    v_exp_f32 v46, v46
    v_exp_f32 v47, v47
L_T30_29:
L_P_T30:
    v_exp_f32 v48, v48
    v_exp_f32 v49, v49
    v_smfmac_f32_32x32x32_bf16 v[80:95], v[20:23], v[40:47], v64
    s_waitcnt lgkmcnt(1)
    ds_read_b128 v[20:23], v4 offset:10320
    v_exp_f32 v50, v50
    v_exp_f32 v51, v51
    v_exp_f32 v52, v52
    v_exp_f32 v53, v53
    v_mfma_f32_32x32x16_bf16 v[32:47], v[12:15], v[8:11], 0
    s_waitcnt lgkmcnt(1)
    ds_read_b128 v[12:15], v5 offset:14448
    buffer_load_dword v142, v141, s[12:15], 0 offen sc1
    v_exp_f32 v54, v54
    v_exp_f32 v55, v55
    v_exp_f32 v56, v56
    v_exp_f32 v57, v57
    v_exp_f32 v58, v58
    v_smfmac_f32_32x32x32_bf16 v[80:95], v[16:19], v[48:55], v64
    s_waitcnt lgkmcnt(1)
    ds_read_b128 v[16:19], v3 offset:12384
    v_exp_f32 v59, v59
    v_exp_f32 v60, v60
    v_exp_f32 v61, v61
    v_exp_f32 v62, v62
    v_exp_f32 v63, v63
L_T31_30:
L_P_T31:
    v_exp_f32 v32, v32
    v_exp_f32 v33, v33
    v_smfmac_f32_32x32x32_bf16 v[80:95], v[20:23], v[56:63], v64
    s_waitcnt lgkmcnt(1)
    ds_read_b128 v[20:23], v4 offset:12384
    v_exp_f32 v34, v34
    v_exp_f32 v35, v35
    v_exp_f32 v36, v36
    v_exp_f32 v37, v37
    v_mfma_f32_32x32x16_bf16 v[48:63], v[12:15], v[8:11], 0
    s_waitcnt lgkmcnt(1)
    ds_read_b128 v[12:15], v5 offset:16512
    v_exp_f32 v38, v38
    v_exp_f32 v39, v39
    v_exp_f32 v40, v40
    v_exp_f32 v41, v41
    v_exp_f32 v42, v42
    v_smfmac_f32_32x32x32_bf16 v[80:95], v[16:19], v[32:39], v64
    s_waitcnt lgkmcnt(1)
    ds_read_b128 v[16:19], v3 offset:14448
    v_exp_f32 v43, v43
    v_exp_f32 v44, v44
    v_exp_f32 v45, v45
    v_exp_f32 v46, v46
    v_exp_f32 v47, v47
L_T32_31:
L_P_T32:
    v_exp_f32 v48, v48
    v_exp_f32 v49, v49
    v_smfmac_f32_32x32x32_bf16 v[80:95], v[20:23], v[40:47], v64
    s_waitcnt lgkmcnt(1)
    ds_read_b128 v[20:23], v4 offset:14448
    v_exp_f32 v50, v50
    v_exp_f32 v51, v51
    v_exp_f32 v52, v52
    v_exp_f32 v53, v53
    v_mfma_f32_32x32x16_bf16 v[32:47], v[12:15], v[8:11], 0
    s_waitcnt lgkmcnt(1)
    ds_read_b128 v[12:15], v5 offset:18576
    v_exp_f32 v54, v54
    v_exp_f32 v55, v55
    v_exp_f32 v56, v56
    v_exp_f32 v57, v57
    v_exp_f32 v58, v58
    v_smfmac_f32_32x32x32_bf16 v[80:95], v[16:19], v[48:55], v64
    s_waitcnt lgkmcnt(1)
    ds_read_b128 v[16:19], v3 offset:16512
    v_exp_f32 v59, v59
    v_exp_f32 v60, v60
    v_exp_f32 v61, v61
    v_exp_f32 v62, v62
    v_exp_f32 v63, v63
    s_waitcnt vmcnt(0)
    s_mov_b64 exec, 1
    v_mov_b32 v28, 3
    buffer_store_dword v28, v139, s[12:15], s60 offen sc1
    s_mov_b64 exec, -1
    s_branch L_common
.p2align 6
L_lseg:
L_T33_0:
L_P_T33:
    v_exp_f32 v32, v32
    v_exp_f32 v33, v33
    s_waitcnt lgkmcnt(1)
    ds_read_b128 v[20:23], v4 offset:0
    s_and_b32 s34, s43, s42
    s_cbranch_scc0 L_pa2
    s_mov_b32 m0, s41
    s_ff1_i32_b32 s28, s34
    s_bitset0_b32 s42, s28
    s_lshl_b32 s28, s28, 13
    s_add_u32 s33, s28, s40
    buffer_load_dwordx4 v2, s[12:15], s33 offen sc1 lds
    buffer_load_dwordx4 v2, s[12:15], s33 offen offset:1024 sc1 lds
    s_add_u32 s44, s44, 1
L_pa2:
    s_and_b32 s75, s20, 3
    s_lshr_b32 s76, s21, 2
    s_lshl_b32 s76, s76, 3
    v_exp_f32 v34, v34
    v_exp_f32 v35, v35
    v_exp_f32 v36, v36
    v_exp_f32 v37, v37
    v_mfma_f32_32x32x16_bf16 v[48:63], v[12:15], v[8:11], 0
    s_waitcnt lgkmcnt(1)
    ds_read_b128 v[12:15], v5 offset:4128
    s_and_b32 s79, s21, 3
    s_lshl_b32 s79, s79, 1
    s_add_u32 s76, s76, s79
    v_exp_f32 v38, v38
    v_exp_f32 v39, v39
    v_exp_f32 v40, v40
    v_exp_f32 v41, v41
    v_exp_f32 v42, v42
    v_smfmac_f32_32x32x32_bf16 v[80:95], v[16:19], v[32:39], v64
    s_waitcnt lgkmcnt(1)
    ds_read_b128 v[16:19], v3 offset:2064
    s_lshr_b32 s79, s20, 2
    s_add_u32 s76, s76, s79
    s_lshr_b32 s79, s75, 1
    v_exp_f32 v43, v43
    v_exp_f32 v44, v44
    v_exp_f32 v45, v45
    v_exp_f32 v46, v46
    v_exp_f32 v47, v47
L_T34_1:
L_P_T34:
    v_exp_f32 v48, v48
    v_exp_f32 v49, v49
    v_smfmac_f32_32x32x32_bf16 v[80:95], v[20:23], v[40:47], v64
    s_waitcnt lgkmcnt(1)
    ds_read_b128 v[20:23], v4 offset:2064
    s_cmp_eq_u32 s34, 0
    s_cbranch_scc1 L_pb2
    s_add_u32 m0, s41, 16
    s_add_u32 s41, s41, 16512
    buffer_load_dwordx4 v2, s[12:15], s33 offen offset:2048 sc1 lds
    buffer_load_dwordx4 v2, s[12:15], s33 offen offset:3072 sc1 lds
L_pb2:
    s_lshl_b32 s70, s22, 1
    s_add_u32 s70, s70, s79
    s_xor_b32 s71, s70, 1
    v_exp_f32 v50, v50
    v_exp_f32 v51, v51
    v_exp_f32 v52, v52
    v_exp_f32 v53, v53
    v_mfma_f32_32x32x16_bf16 v[32:47], v[12:15], v[8:11], 0
    s_waitcnt lgkmcnt(1)
    ds_read_b128 v[12:15], v5 offset:6192
    s_lshl_b32 s77, s75, 13
    s_lshl_b32 s70, s70, 15
    s_lshl_b32 s71, s71, 15
    v_exp_f32 v54, v54
    v_exp_f32 v55, v55
    v_exp_f32 v56, v56
    v_exp_f32 v57, v57
    v_exp_f32 v58, v58
    v_smfmac_f32_32x32x32_bf16 v[80:95], v[16:19], v[48:55], v64
    s_waitcnt lgkmcnt(1)
    ds_read_b128 v[16:19], v3 offset:4128
    s_lshl_b32 s72, s76, 15
    s_add_u32 s72, s72, s77
    v_exp_f32 v59, v59
    v_exp_f32 v60, v60
    v_exp_f32 v61, v61
    v_exp_f32 v62, v62
    v_exp_f32 v63, v63
L_T35_2:
L_P_T35:
    v_exp_f32 v32, v32
    v_exp_f32 v33, v33
    v_smfmac_f32_32x32x32_bf16 v[80:95], v[20:23], v[56:63], v64
    s_waitcnt lgkmcnt(1)
    ds_read_b128 v[20:23], v4 offset:4128
    s_add_u32 s77, s77, 14680064
    s_add_u32 s70, s70, s77
    s_add_u32 s71, s71, s77
    v_exp_f32 v34, v34
    v_exp_f32 v35, v35
    v_exp_f32 v36, v36
    v_exp_f32 v37, v37
    v_mfma_f32_32x32x16_bf16 v[48:63], v[12:15], v[8:11], 0
    s_waitcnt lgkmcnt(1)
    ds_read_b128 v[12:15], v5 offset:8256
    v_mov_b32 v24, -1
    v_mov_b32 v25, -1
    v_mov_b32 v26, -1
    v_mov_b32 v27, -1
    s_sub_u32 s28, s57, 32768
    buffer_store_dwordx4 v[24:27], v2, s[12:15], s57 offen sc1
    buffer_store_dwordx4 v[24:27], v2, s[12:15], s28 offen sc1
    s_and_b32 s77, s22, 6
    s_and_b32 s79, s22, 1
    s_lshl_b32 s79, s79, 7
    v_exp_f32 v38, v38
    v_exp_f32 v39, v39
    v_exp_f32 v40, v40
    v_exp_f32 v41, v41
    v_exp_f32 v42, v42
    v_smfmac_f32_32x32x32_bf16 v[80:95], v[16:19], v[32:39], v64
    s_waitcnt lgkmcnt(1)
    ds_read_b128 v[16:19], v3 offset:6192
    s_add_u32 s77, s77, s79
    s_lshl_b32 s79, s75, 5
    s_add_u32 s77, s77, s79
    v_exp_f32 v43, v43
    v_exp_f32 v44, v44
    v_exp_f32 v45, v45
    v_exp_f32 v46, v46
    v_exp_f32 v47, v47
L_T36_3:
L_P_T36:
    v_exp_f32 v48, v48
    v_exp_f32 v49, v49
    v_smfmac_f32_32x32x32_bf16 v[80:95], v[20:23], v[40:47], v64
    s_waitcnt lgkmcnt(1)
    ds_read_b128 v[20:23], v4 offset:6192
    s_andn2_b32 s28, s42, s43
    s_cbranch_scc0 L_r3
    v_add_u32 v29, -1, v30
    v_cmp_gt_u32 vcc, 3, v29
    s_nop 0
    s_lshr_b32 s28, vcc_lo, 1
    s_and_b32 s28, s28, vcc_lo
    s_and_b32 s28, s28, 0x5555
    s_or_b32 s43, s43, s28
    s_andn2_b32 s28, s42, s43
    s_cbranch_scc0 L_r3
    s_mul_i32 exec_lo, s28, 3
    s_mov_b32 exec_hi, 0
    buffer_load_dword v30, v31, s[12:15], s45 offen sc1
    s_mov_b64 exec, -1
L_r3:
    s_and_b32 s34, s43, s42
    s_cbranch_scc0 L_pa3
    s_mov_b32 m0, s41
    s_ff1_i32_b32 s28, s34
    s_bitset0_b32 s42, s28
    s_lshl_b32 s28, s28, 13
    s_add_u32 s33, s28, s40
    buffer_load_dwordx4 v2, s[12:15], s33 offen sc1 lds
    buffer_load_dwordx4 v2, s[12:15], s33 offen offset:1024 sc1 lds
    s_add_u32 s44, s44, 1
L_pa3:
    s_add_u32 s77, s77, 124928
    s_lshl_b32 s77, s77, 7
    v_bfe_u32 v108, v1, 2, 2
    v_exp_f32 v50, v50
    v_exp_f32 v51, v51
    v_exp_f32 v52, v52
    v_exp_f32 v53, v53
    v_mfma_f32_32x32x16_bf16 v[32:47], v[12:15], v[8:11], 0
    s_waitcnt lgkmcnt(1)
    ds_read_b128 v[12:15], v5 offset:10320
    v_and_b32 v110, 3, v1
    v_bfe_u32 v109, v1, 4, 1
    v_exp_f32 v54, v54
    v_exp_f32 v55, v55
    v_exp_f32 v56, v56
    v_exp_f32 v57, v57
    v_exp_f32 v58, v58
    v_smfmac_f32_32x32x32_bf16 v[80:95], v[16:19], v[48:55], v64
    s_waitcnt lgkmcnt(1)
    ds_read_b128 v[16:19], v3 offset:8256
    v_lshl_add_u32 v141, v108, 10, s77
    v_lshl_add_u32 v141, v109, 7, v141
    s_lshl_b32 s78, s75, 1
    v_exp_f32 v59, v59
    v_exp_f32 v60, v60
    v_exp_f32 v61, v61
    v_exp_f32 v62, v62
    v_exp_f32 v63, v63
L_T37_4:
L_P_T37:
    v_exp_f32 v32, v32
    v_exp_f32 v33, v33
    v_smfmac_f32_32x32x32_bf16 v[80:95], v[20:23], v[56:63], v64
    s_waitcnt lgkmcnt(1)
    ds_read_b128 v[20:23], v4 offset:8256
    s_cmp_eq_u32 s34, 0
    s_cbranch_scc1 L_pb3
    s_add_u32 m0, s41, 16
    s_add_u32 s41, s41, 16512
    buffer_load_dwordx4 v2, s[12:15], s33 offen offset:2048 sc1 lds
    buffer_load_dwordx4 v2, s[12:15], s33 offen offset:3072 sc1 lds
L_pb3:
    s_add_u32 s78, s78, 124928
    s_lshr_b32 s77, s76, 5
    s_add_u32 s77, s77, s78
    v_exp_f32 v34, v34
    v_exp_f32 v35, v35
    v_exp_f32 v36, v36
    v_exp_f32 v37, v37
    v_mfma_f32_32x32x16_bf16 v[48:63], v[12:15], v[8:11], 0
    s_waitcnt lgkmcnt(1)
    ds_read_b128 v[12:15], v5 offset:12384
    s_bfe_u32 s79, s76, 0x40001
    s_lshl_b32 s79, s79, 3
    s_add_u32 s77, s77, s79
    v_exp_f32 v38, v38
    v_exp_f32 v39, v39
    v_exp_f32 v40, v40
    v_exp_f32 v41, v41
    v_exp_f32 v42, v42
    v_smfmac_f32_32x32x32_bf16 v[80:95], v[16:19], v[32:39], v64
    s_waitcnt lgkmcnt(1)
    ds_read_b128 v[16:19], v3 offset:10320
    s_lshl_b32 s77, s77, 7
    s_mov_b32 exec_lo, 0
    v_lshl_add_u32 v141, v109, 14, s77
    s_mov_b32 exec_lo, -1
    v_lshl_add_u32 v141, v110, 2, v141
    v_exp_f32 v43, v43
    v_exp_f32 v44, v44
    v_exp_f32 v45, v45
    v_exp_f32 v46, v46
    v_exp_f32 v47, v47
L_T38_5:
L_P_T38:
    v_exp_f32 v48, v48
    v_exp_f32 v49, v49
    v_smfmac_f32_32x32x32_bf16 v[80:95], v[20:23], v[40:47], v64
    s_waitcnt lgkmcnt(1)
    ds_read_b128 v[20:23], v4 offset:10320
    s_lshr_b32 s77, s76, 3
    s_lshl_b32 s77, s77, 5
    v_exp_f32 v50, v50
    v_exp_f32 v51, v51
    v_exp_f32 v52, v52
    v_exp_f32 v53, v53
    v_mfma_f32_32x32x16_bf16 v[32:47], v[12:15], v[8:11], 0
    s_waitcnt lgkmcnt(1)
    ds_read_b128 v[12:15], v5 offset:14448
    s_add_u32 s77, s77, s78
    s_lshl_b32 s77, s77, 7
    s_add_u32 s77, s77, 16
    v_exp_f32 v54, v54
    v_exp_f32 v55, v55
    v_exp_f32 v56, v56
    v_exp_f32 v57, v57
    v_exp_f32 v58, v58
    v_smfmac_f32_32x32x32_bf16 v[80:95], v[16:19], v[48:55], v64
    s_waitcnt lgkmcnt(1)
    ds_read_b128 v[16:19], v3 offset:12384
    v_lshl_add_u32 v108, v109, 7, s77
    s_and_b32 s77, s26, 6
    s_and_b32 s79, s26, 1
    v_exp_f32 v59, v59
    v_exp_f32 v60, v60
    v_exp_f32 v61, v61
    v_exp_f32 v62, v62
    v_exp_f32 v63, v63
L_T39_6:
L_P_T39:
    v_exp_f32 v32, v32
    v_exp_f32 v33, v33
    v_smfmac_f32_32x32x32_bf16 v[80:95], v[20:23], v[56:63], v64
    s_waitcnt lgkmcnt(1)
    ds_read_b128 v[20:23], v4 offset:12384
    s_lshl_b32 s79, s79, 7
    s_add_u32 s77, s77, s79
    s_lshr_b32 s79, s56, 5
    v_exp_f32 v34, v34
    v_exp_f32 v35, v35
    v_exp_f32 v36, v36
    v_exp_f32 v37, v37
    v_mfma_f32_32x32x16_bf16 v[48:63], v[12:15], v[8:11], 0
    s_waitcnt lgkmcnt(1)
    ds_read_b128 v[12:15], v5 offset:16512
    s_add_u32 s77, s77, s79
    s_bfe_u32 s79, s56, 0x40001
    s_lshl_b32 s79, s79, 3
    v_exp_f32 v38, v38
    v_exp_f32 v39, v39
    v_exp_f32 v40, v40
    v_exp_f32 v41, v41
    v_exp_f32 v42, v42
    v_smfmac_f32_32x32x32_bf16 v[80:95], v[16:19], v[32:39], v64
    s_waitcnt lgkmcnt(1)
    ds_read_b128 v[16:19], v3 offset:14448
    s_add_u32 s77, s77, s79
    s_lshl_b32 s77, s77, 5
    v_exp_f32 v43, v43
    v_exp_f32 v44, v44
    v_exp_f32 v45, v45
    v_exp_f32 v46, v46
    v_exp_f32 v47, v47
L_T40_7:
L_P_T40:
    s_setprio 2
    v_exp_f32 v48, v48
    v_exp_f32 v49, v49
    v_smfmac_f32_32x32x32_bf16 v[80:95], v[20:23], v[40:47], v64
    s_waitcnt lgkmcnt(1)
    ds_read_b128 v[20:23], v4 offset:14448
    s_andn2_b32 s28, s42, s43
    s_cbranch_scc0 L_r4
    v_add_u32 v29, -1, v30
    v_cmp_gt_u32 vcc, 3, v29
    s_nop 0
    s_lshr_b32 s28, vcc_lo, 1
    s_and_b32 s28, s28, vcc_lo
    s_and_b32 s28, s28, 0x5555
    s_or_b32 s43, s43, s28
    s_andn2_b32 s28, s42, s43
    s_cbranch_scc0 L_r4
    s_mul_i32 exec_lo, s28, 3
    s_mov_b32 exec_hi, 0
    buffer_load_dword v30, v31, s[12:15], s45 offen sc1
    s_mov_b64 exec, -1
L_r4:
    s_and_b32 s34, s43, s42
    s_cbranch_scc0 L_pa4
    s_mov_b32 m0, s41
    s_ff1_i32_b32 s28, s34
    s_bitset0_b32 s42, s28
    s_lshl_b32 s28, s28, 13
    s_add_u32 s33, s28, s40
    buffer_load_dwordx4 v2, s[12:15], s33 offen sc1 lds
    buffer_load_dwordx4 v2, s[12:15], s33 offen offset:1024 sc1 lds
    s_add_u32 s44, s44, 1
L_pa4:
    s_and_b32 s79, s56, 1
    s_add_u32 s77, s77, s79
    s_and_b32 s79, s21, 2
    v_exp_f32 v50, v50
    v_exp_f32 v51, v51
    v_exp_f32 v52, v52
    v_exp_f32 v53, v53
    v_mfma_f32_32x32x16_bf16 v[32:47], v[12:15], v[8:11], 0
    s_waitcnt lgkmcnt(1)
    ds_read_b128 v[12:15], v5 offset:18576
    s_add_u32 s77, s77, s79
    s_lshl_b32 s77, s77, 2
    s_add_u32 s77, s77, 15990784
    v_exp_f32 v54, v54
    v_exp_f32 v55, v55
    v_exp_f32 v56, v56
    v_exp_f32 v57, v57
    v_exp_f32 v58, v58
    v_smfmac_f32_32x32x32_bf16 v[80:95], v[16:19], v[48:55], v64
    s_waitcnt lgkmcnt(1)
    ds_read_b128 v[16:19], v3 offset:16512
    s_mov_b32 exec_lo, 0
    s_mov_b32 exec_hi, 0x00f000f0
    v_lshl_add_u32 v141, v110, 10, v108
    s_mov_b32 exec_hi, 0xff00ff00
    v_mov_b32 v141, s77
    s_mov_b64 exec, -1
    s_and_b32 s88, s75, 1
    s_lshl_b32 s88, s88, 8
    v_exp_f32 v59, v59
    v_exp_f32 v60, v60
    v_exp_f32 v61, v61
    v_exp_f32 v62, v62
    v_exp_f32 v63, v63
L_T41_8:
L_P_T41:
    v_exp_f32 v32, v32
    v_exp_f32 v33, v33
    v_smfmac_f32_32x32x32_bf16 v[80:95], v[20:23], v[56:63], v64
    s_waitcnt lgkmcnt(1)
    ds_read_b128 v[20:23], v4 offset:16512
    s_cmp_eq_u32 s34, 0
    s_cbranch_scc1 L_pb4
    s_add_u32 m0, s41, 16
    s_add_u32 s41, s41, 16512
    buffer_load_dwordx4 v2, s[12:15], s33 offen offset:2048 sc1 lds
    buffer_load_dwordx4 v2, s[12:15], s33 offen offset:3072 sc1 lds
L_pb4:
    s_cmp_lt_u32 s20, 4
    s_cselect_b32 s77, 132096, 0
    s_xor_b32 s79, s75, 1
    s_mul_i32 s79, s79, 6144
    v_exp_f32 v34, v34
    v_exp_f32 v35, v35
    v_exp_f32 v36, v36
    v_exp_f32 v37, v37
    v_mfma_f32_32x32x16_bf16 v[48:63], v[12:15], v[8:11], 0
    s_waitcnt lgkmcnt(1)
    ds_read_b128 v[12:15], v5 offset:20640
    s_add_u32 s79, s79, s77
    s_add_u32 s84, s79, 0
    v_exp_f32 v38, v38
    v_exp_f32 v39, v39
    v_exp_f32 v40, v40
    v_exp_f32 v41, v41
    v_exp_f32 v42, v42
    v_smfmac_f32_32x32x32_bf16 v[80:95], v[16:19], v[32:39], v64
    s_waitcnt lgkmcnt(1)
    ds_read_b128 v[16:19], v3 offset:18576
    s_xor_b32 s79, s75, 2
    s_mul_i32 s79, s79, 6144
    s_add_u32 s79, s79, s77
    v_exp_f32 v43, v43
    v_exp_f32 v44, v44
    v_exp_f32 v45, v45
    v_exp_f32 v46, v46
    v_exp_f32 v47, v47
L_T42_9:
L_P_T42:
    v_exp_f32 v48, v48
    v_exp_f32 v49, v49
    v_smfmac_f32_32x32x32_bf16 v[80:95], v[20:23], v[40:47], v64
    s_waitcnt lgkmcnt(1)
    ds_read_b128 v[20:23], v4 offset:18576
    s_add_u32 s85, s79, 2048
    s_xor_b32 s79, s75, 3
    s_mul_i32 s79, s79, 6144
    v_exp_f32 v50, v50
    v_exp_f32 v51, v51
    v_exp_f32 v52, v52
    v_exp_f32 v53, v53
    v_mfma_f32_32x32x16_bf16 v[32:47], v[12:15], v[8:11], 0
    s_waitcnt lgkmcnt(1)
    ds_read_b128 v[12:15], v5 offset:22704
    s_add_u32 s79, s79, s77
    s_add_u32 s86, s79, 4096
    s_mul_i32 s79, s75, 6144
    v_exp_f32 v54, v54
    v_exp_f32 v55, v55
    v_exp_f32 v56, v56
    v_exp_f32 v57, v57
    v_exp_f32 v58, v58
    v_smfmac_f32_32x32x32_bf16 v[80:95], v[16:19], v[48:55], v64
    s_waitcnt lgkmcnt(1)
    ds_read_b128 v[16:19], v3 offset:20640
    s_add_u32 s87, s79, s77
    s_lshr_b32 s77, s76, 1
    s_lshl_b32 s77, s77, 6
    v_exp_f32 v59, v59
    v_exp_f32 v60, v60
    v_exp_f32 v61, v61
    v_exp_f32 v62, v62
    v_exp_f32 v63, v63
L_T43_10:
L_P_T43:
    v_exp_f32 v32, v32
    v_exp_f32 v33, v33
    v_smfmac_f32_32x32x32_bf16 v[80:95], v[20:23], v[56:63], v64
    s_waitcnt lgkmcnt(1)
    ds_read_b128 v[20:23], v4 offset:20640
    s_andn2_b32 s28, s42, s43
    s_cbranch_scc0 L_r5
    v_add_u32 v29, -1, v30
    v_cmp_gt_u32 vcc, 3, v29
    s_nop 0
    s_lshr_b32 s28, vcc_lo, 1
    s_and_b32 s28, s28, vcc_lo
    s_and_b32 s28, s28, 0x5555
    s_or_b32 s43, s43, s28
    s_andn2_b32 s28, s42, s43
    s_cbranch_scc0 L_r5
    s_mul_i32 exec_lo, s28, 3
    s_mov_b32 exec_hi, 0
    buffer_load_dword v30, v31, s[12:15], s45 offen sc1
    s_mov_b64 exec, -1
L_r5:
    s_and_b32 s34, s43, s42
    s_cbranch_scc0 L_pa5
    s_mov_b32 m0, s41
    s_ff1_i32_b32 s28, s34
    s_bitset0_b32 s42, s28
    s_lshl_b32 s28, s28, 13
    s_add_u32 s33, s28, s40
    buffer_load_dwordx4 v2, s[12:15], s33 offen sc1 lds
    buffer_load_dwordx4 v2, s[12:15], s33 offen offset:1024 sc1 lds
    s_add_u32 s44, s44, 1
L_pa5:
    s_and_b32 s79, s76, 1
    s_add_u32 s77, s77, s79
    v_exp_f32 v34, v34
    v_exp_f32 v35, v35
    v_exp_f32 v36, v36
    v_exp_f32 v37, v37
    v_mfma_f32_32x32x16_bf16 v[48:63], v[12:15], v[8:11], 0
    s_waitcnt lgkmcnt(1)
    ds_read_b128 v[12:15], v5 offset:24768
    s_lshl_b32 s77, s77, 10
    s_lshl_b32 s73, s22, 7
    s_add_u32 s73, s73, s77
    v_exp_f32 v38, v38
    v_exp_f32 v39, v39
    v_exp_f32 v40, v40
    v_exp_f32 v41, v41
    v_exp_f32 v42, v42
    v_smfmac_f32_32x32x32_bf16 v[80:95], v[16:19], v[32:39], v64
    s_waitcnt lgkmcnt(1)
    ds_read_b128 v[16:19], v3 offset:22704
    s_lshl_b32 s79, s75, 5
    s_add_u32 s73, s73, s79
    s_lshr_b32 s74, s21, 1
    v_exp_f32 v43, v43
    v_exp_f32 v44, v44
    v_exp_f32 v45, v45
    v_exp_f32 v46, v46
    v_exp_f32 v47, v47
L_T44_11:
L_P_T44:
    s_setprio 1
    v_exp_f32 v48, v48
    v_exp_f32 v49, v49
    v_smfmac_f32_32x32x32_bf16 v[80:95], v[20:23], v[40:47], v64
    s_waitcnt lgkmcnt(1)
    ds_read_b128 v[20:23], v4 offset:22704
    s_cmp_eq_u32 s34, 0
    s_cbranch_scc1 L_pb5
    s_add_u32 m0, s41, 16
    s_add_u32 s41, s41, 16512
    buffer_load_dwordx4 v2, s[12:15], s33 offen offset:2048 sc1 lds
    buffer_load_dwordx4 v2, s[12:15], s33 offen offset:3072 sc1 lds
L_pb5:
    s_lshl_b32 s74, s74, 6
    s_add_u32 s74, s74, s56
    s_lshl_b32 s74, s74, 7
    v_exp_f32 v50, v50
    v_exp_f32 v51, v51
    v_exp_f32 v52, v52
    v_exp_f32 v53, v53
    v_mfma_f32_32x32x16_bf16 v[32:47], v[12:15], v[8:11], 0
    s_waitcnt lgkmcnt(1)
    ds_read_b128 v[12:15], v5 offset:26832
    s_add_u32 s74, s74, 15728640
    s_mov_b32 s80, s50
    s_mov_b32 s81, s51
    v_exp_f32 v54, v54
    v_exp_f32 v55, v55
    v_exp_f32 v56, v56
    v_exp_f32 v57, v57
    v_exp_f32 v58, v58
    v_smfmac_f32_32x32x32_bf16 v[80:95], v[16:19], v[48:55], v64
    s_waitcnt lgkmcnt(1)
    ds_read_b128 v[16:19], v3 offset:24768
    s_mov_b32 s82, 0x200000
    s_mov_b32 s83, 0x00020000
    v_exp_f32 v59, v59
    v_exp_f32 v60, v60
    v_exp_f32 v61, v61
    v_exp_f32 v62, v62
    v_exp_f32 v63, v63
L_T45_12:
L_P_T45:
    v_exp_f32 v32, v32
    v_exp_f32 v33, v33
    v_smfmac_f32_32x32x32_bf16 v[80:95], v[20:23], v[56:63], v64
    s_waitcnt lgkmcnt(1)
    ds_read_b128 v[20:23], v4 offset:24768
    v_exp_f32 v34, v34
    v_exp_f32 v35, v35
    v_exp_f32 v36, v36
    v_exp_f32 v37, v37
    v_mfma_f32_32x32x16_bf16 v[48:63], v[12:15], v[8:11], 0
    s_waitcnt lgkmcnt(1)
    ds_read_b128 v[12:15], v5 offset:28896
    v_exp_f32 v38, v38
    v_exp_f32 v39, v39
    v_exp_f32 v40, v40
    v_exp_f32 v41, v41
    v_exp_f32 v42, v42
    v_smfmac_f32_32x32x32_bf16 v[80:95], v[16:19], v[32:39], v64
    s_waitcnt lgkmcnt(1)
    ds_read_b128 v[16:19], v3 offset:26832
    v_exp_f32 v43, v43
    v_exp_f32 v44, v44
    v_exp_f32 v45, v45
    v_exp_f32 v46, v46
    v_exp_f32 v47, v47
L_T46_13:
L_P_T46:
    s_setprio 0
    v_exp_f32 v48, v48
    v_exp_f32 v49, v49
    v_smfmac_f32_32x32x32_bf16 v[80:95], v[20:23], v[40:47], v64
    s_waitcnt lgkmcnt(1)
    ds_read_b128 v[20:23], v4 offset:26832
    v_exp_f32 v50, v50
    v_exp_f32 v51, v51
    v_exp_f32 v52, v52
    v_exp_f32 v53, v53
    v_mfma_f32_32x32x16_bf16 v[32:47], v[12:15], v[8:11], 0
    s_waitcnt lgkmcnt(1)
    ds_read_b128 v[12:15], v5 offset:30960
    v_exp_f32 v54, v54
    v_exp_f32 v55, v55
    v_exp_f32 v56, v56
    v_exp_f32 v57, v57
    v_exp_f32 v58, v58
    v_smfmac_f32_32x32x32_bf16 v[80:95], v[16:19], v[48:55], v64
    s_waitcnt lgkmcnt(1)
    ds_read_b128 v[16:19], v3 offset:28896
    v_exp_f32 v59, v59
    v_exp_f32 v60, v60
    v_exp_f32 v61, v61
    v_exp_f32 v62, v62
    v_exp_f32 v63, v63
L_T47_14:
L_P_T47:
    s_cmp_lt_u32 s44, 4
    s_cbranch_scc1 L_slow1
L_slow1_ret:
    s_waitcnt vmcnt(0)
    s_barrier
    s_setprio 3
    v_exp_f32 v32, v32
    v_exp_f32 v33, v33
    v_smfmac_f32_32x32x32_bf16 v[80:95], v[20:23], v[56:63], v64
    s_waitcnt lgkmcnt(1)
    ds_read_b128 v[20:23], v4 offset:28896
    s_andn2_b32 s28, s42, s43
    s_cbranch_scc0 L_r6
    v_add_u32 v29, -1, v30
    v_cmp_gt_u32 vcc, 3, v29
    s_nop 0
    s_lshr_b32 s28, vcc_lo, 1
    s_and_b32 s28, s28, vcc_lo
    s_and_b32 s28, s28, 0x5555
    s_or_b32 s43, s43, s28
    s_andn2_b32 s28, s42, s43
    s_cbranch_scc0 L_r6
    s_mul_i32 exec_lo, s28, 3
    s_mov_b32 exec_hi, 0
    buffer_load_dword v30, v31, s[12:15], s45 offen sc1
    s_mov_b64 exec, -1
L_r6:
    s_and_b32 s34, s43, s42
    s_cbranch_scc0 L_pa6
    s_mov_b32 m0, s41
    s_ff1_i32_b32 s28, s34
    s_bitset0_b32 s42, s28
    s_lshl_b32 s28, s28, 13
    s_add_u32 s33, s28, s40
    buffer_load_dwordx4 v2, s[12:15], s33 offen sc1 lds
    buffer_load_dwordx4 v2, s[12:15], s33 offen offset:1024 sc1 lds
    s_add_u32 s44, s44, 1
L_pa6:
    v_exp_f32 v34, v34
    v_exp_f32 v35, v35
    v_exp_f32 v36, v36
    v_exp_f32 v37, v37
    v_mfma_f32_32x32x16_bf16 v[48:63], v[12:15], v[8:11], 0
    s_waitcnt lgkmcnt(1)
    ds_read_b128 v[12:15], v5 offset:33024
    v_exp_f32 v38, v38
    v_exp_f32 v39, v39
    v_exp_f32 v40, v40
    v_exp_f32 v41, v41
    v_exp_f32 v42, v42
    v_smfmac_f32_32x32x32_bf16 v[80:95], v[16:19], v[32:39], v64
    s_waitcnt lgkmcnt(1)
    ds_read_b128 v[16:19], v3 offset:30960
    v_exp_f32 v43, v43
    v_exp_f32 v44, v44
    v_exp_f32 v45, v45
    v_exp_f32 v46, v46
    v_exp_f32 v47, v47
L_T48_15:
L_P_T48:
    v_exp_f32 v48, v48
    v_exp_f32 v49, v49
    v_smfmac_f32_32x32x32_bf16 v[80:95], v[20:23], v[40:47], v64
    s_waitcnt lgkmcnt(1)
    ds_read_b128 v[20:23], v4 offset:30960
    s_cmp_eq_u32 s34, 0
    s_cbranch_scc1 L_pb6
    s_add_u32 m0, s41, 16
    s_add_u32 s41, s41, 16512
    buffer_load_dwordx4 v2, s[12:15], s33 offen offset:2048 sc1 lds
    buffer_load_dwordx4 v2, s[12:15], s33 offen offset:3072 sc1 lds
L_pb6:
    v_exp_f32 v50, v50
    v_exp_f32 v51, v51
    v_exp_f32 v52, v52
    v_exp_f32 v53, v53
    v_mfma_f32_32x32x16_bf16 v[32:47], v[12:15], v[8:11], 0
    s_waitcnt lgkmcnt(1)
    ds_read_b128 v[12:15], v5 offset:35088
    v_exp_f32 v54, v54
    v_exp_f32 v55, v55
    v_exp_f32 v56, v56
    v_exp_f32 v57, v57
    v_exp_f32 v58, v58
    v_smfmac_f32_32x32x32_bf16 v[80:95], v[16:19], v[48:55], v64
    s_waitcnt lgkmcnt(1)
    ds_read_b128 v[16:19], v3 offset:33024
    v_exp_f32 v59, v59
    v_exp_f32 v60, v60
    v_exp_f32 v61, v61
    v_exp_f32 v62, v62
    v_exp_f32 v63, v63
L_T49_16:
L_P_T49:
    v_exp_f32 v32, v32
    v_exp_f32 v33, v33
    v_smfmac_f32_32x32x32_bf16 v[80:95], v[20:23], v[56:63], v64
    s_waitcnt lgkmcnt(1)
    ds_read_b128 v[20:23], v4 offset:33024
    v_exp_f32 v34, v34
    v_exp_f32 v35, v35
    v_exp_f32 v36, v36
    v_exp_f32 v37, v37
    v_mfma_f32_32x32x16_bf16 v[48:63], v[12:15], v[8:11], 0
    s_waitcnt lgkmcnt(1)
    ds_read_b128 v[12:15], v5 offset:37152
    v_exp_f32 v38, v38
    v_exp_f32 v39, v39
    v_exp_f32 v40, v40
    v_exp_f32 v41, v41
    v_exp_f32 v42, v42
    v_smfmac_f32_32x32x32_bf16 v[80:95], v[16:19], v[32:39], v64
    s_waitcnt lgkmcnt(1)
    ds_read_b128 v[16:19], v3 offset:35088
    v_exp_f32 v43, v43
    v_exp_f32 v44, v44
    v_exp_f32 v45, v45
    v_exp_f32 v46, v46
    v_exp_f32 v47, v47
L_T50_17:
L_P_T50:
    s_setprio 2
    v_exp_f32 v48, v48
    v_exp_f32 v49, v49
    v_smfmac_f32_32x32x32_bf16 v[80:95], v[20:23], v[40:47], v64
    s_waitcnt lgkmcnt(1)
    ds_read_b128 v[20:23], v4 offset:35088
    s_andn2_b32 s28, s42, s43
    s_cbranch_scc0 L_r7
    v_add_u32 v29, -1, v30
    v_cmp_gt_u32 vcc, 3, v29
    s_nop 0
    s_lshr_b32 s28, vcc_lo, 1
    s_and_b32 s28, s28, vcc_lo
    s_and_b32 s28, s28, 0x5555
    s_or_b32 s43, s43, s28
    s_andn2_b32 s28, s42, s43
    s_cbranch_scc0 L_r7
    s_mul_i32 exec_lo, s28, 3
    s_mov_b32 exec_hi, 0
    buffer_load_dword v30, v31, s[12:15], s45 offen sc1
    s_mov_b64 exec, -1
L_r7:
    s_and_b32 s34, s43, s42
    s_cbranch_scc0 L_pa7
    s_mov_b32 m0, s41
    s_ff1_i32_b32 s28, s34
    s_bitset0_b32 s42, s28
    s_lshl_b32 s28, s28, 13
    s_add_u32 s33, s28, s40
    buffer_load_dwordx4 v2, s[12:15], s33 offen sc1 lds
    buffer_load_dwordx4 v2, s[12:15], s33 offen offset:1024 sc1 lds
    s_add_u32 s44, s44, 1
L_pa7:
    v_exp_f32 v50, v50
    v_exp_f32 v51, v51
    v_exp_f32 v52, v52
    v_exp_f32 v53, v53
    v_mfma_f32_32x32x16_bf16 v[32:47], v[12:15], v[8:11], 0
    s_waitcnt lgkmcnt(1)
    ds_read_b128 v[12:15], v5 offset:39216
    v_exp_f32 v54, v54
    v_exp_f32 v55, v55
    v_exp_f32 v56, v56
    v_exp_f32 v57, v57
    v_exp_f32 v58, v58
    v_smfmac_f32_32x32x32_bf16 v[80:95], v[16:19], v[48:55], v64
    s_waitcnt lgkmcnt(1)
    ds_read_b128 v[16:19], v3 offset:37152
    v_exp_f32 v59, v59
    v_exp_f32 v60, v60
    v_exp_f32 v61, v61
    v_exp_f32 v62, v62
    v_exp_f32 v63, v63
L_T51_18:
L_P_T51:
    v_exp_f32 v32, v32
    v_exp_f32 v33, v33
    v_smfmac_f32_32x32x32_bf16 v[80:95], v[20:23], v[56:63], v64
    s_waitcnt lgkmcnt(1)
    ds_read_b128 v[20:23], v4 offset:37152
    s_cmp_eq_u32 s34, 0
    s_cbranch_scc1 L_pb7
    s_add_u32 m0, s41, 16
    s_add_u32 s41, s41, 16512
    buffer_load_dwordx4 v2, s[12:15], s33 offen offset:2048 sc1 lds
    buffer_load_dwordx4 v2, s[12:15], s33 offen offset:3072 sc1 lds
L_pb7:
    v_exp_f32 v34, v34
    v_exp_f32 v35, v35
    v_exp_f32 v36, v36
    v_exp_f32 v37, v37
    v_mfma_f32_32x32x16_bf16 v[48:63], v[12:15], v[8:11], 0
    s_waitcnt lgkmcnt(1)
    ds_read_b128 v[12:15], v5 offset:41280
    v_exp_f32 v38, v38
    v_exp_f32 v39, v39
    v_exp_f32 v40, v40
    v_exp_f32 v41, v41
    v_exp_f32 v42, v42
    v_smfmac_f32_32x32x32_bf16 v[80:95], v[16:19], v[32:39], v64
    s_waitcnt lgkmcnt(1)
    ds_read_b128 v[16:19], v3 offset:39216
    v_exp_f32 v43, v43
    v_exp_f32 v44, v44
    v_exp_f32 v45, v45
    v_exp_f32 v46, v46
    v_exp_f32 v47, v47
L_T52_19:
L_P_T52:
    v_exp_f32 v48, v48
    v_exp_f32 v49, v49
    v_smfmac_f32_32x32x32_bf16 v[80:95], v[20:23], v[40:47], v64
    s_waitcnt lgkmcnt(1)
    ds_read_b128 v[20:23], v4 offset:39216
    v_exp_f32 v50, v50
    v_exp_f32 v51, v51
    v_exp_f32 v52, v52
    v_exp_f32 v53, v53
    v_mfma_f32_32x32x16_bf16 v[32:47], v[12:15], v[8:11], 0
    s_waitcnt lgkmcnt(1)
    ds_read_b128 v[12:15], v5 offset:43344
    v_exp_f32 v54, v54
    v_exp_f32 v55, v55
    v_exp_f32 v56, v56
    v_exp_f32 v57, v57
    v_exp_f32 v58, v58
    v_smfmac_f32_32x32x32_bf16 v[80:95], v[16:19], v[48:55], v64
    s_waitcnt lgkmcnt(1)
    ds_read_b128 v[16:19], v3 offset:41280
    v_exp_f32 v59, v59
    v_exp_f32 v60, v60
    v_exp_f32 v61, v61
    v_exp_f32 v62, v62
    v_exp_f32 v63, v63
L_T53_20:
L_P_T53:
    v_exp_f32 v32, v32
    v_exp_f32 v33, v33
    v_smfmac_f32_32x32x32_bf16 v[80:95], v[20:23], v[56:63], v64
    s_waitcnt lgkmcnt(1)
    ds_read_b128 v[20:23], v4 offset:41280
    v_exp_f32 v34, v34
    v_exp_f32 v35, v35
    v_exp_f32 v36, v36
    v_exp_f32 v37, v37
    v_mfma_f32_32x32x16_bf16 v[48:63], v[12:15], v[8:11], 0
    s_waitcnt lgkmcnt(1)
    ds_read_b128 v[12:15], v5 offset:45408
    v_exp_f32 v38, v38
    v_exp_f32 v39, v39
    v_exp_f32 v40, v40
    v_exp_f32 v41, v41
    v_exp_f32 v42, v42
    v_smfmac_f32_32x32x32_bf16 v[80:95], v[16:19], v[32:39], v64
    s_waitcnt lgkmcnt(1)
    ds_read_b128 v[16:19], v3 offset:43344
    v_xor_b32 v7, s88, v2
    v_exp_f32 v43, v43
    v_exp_f32 v44, v44
    v_exp_f32 v45, v45
    v_exp_f32 v46, v46
    v_exp_f32 v47, v47
L_T54_21:
L_P_T54:
    s_setprio 1
    v_exp_f32 v48, v48
    v_exp_f32 v49, v49
    v_smfmac_f32_32x32x32_bf16 v[80:95], v[20:23], v[40:47], v64
    s_waitcnt lgkmcnt(1)
    ds_read_b128 v[20:23], v4 offset:43344
    v_exp_f32 v50, v50
    v_exp_f32 v51, v51
    v_exp_f32 v52, v52
    v_exp_f32 v53, v53
    v_mfma_f32_32x32x16_bf16 v[32:47], v[12:15], v[8:11], 0
    s_waitcnt lgkmcnt(1)
    ds_read_b128 v[12:15], v5 offset:47472
    v_exp_f32 v54, v54
    v_exp_f32 v55, v55
    v_exp_f32 v56, v56
    v_exp_f32 v57, v57
    v_exp_f32 v58, v58
    v_smfmac_f32_32x32x32_bf16 v[80:95], v[16:19], v[48:55], v64
    s_waitcnt lgkmcnt(1)
    ds_read_b128 v[16:19], v3 offset:45408
    v_exp_f32 v59, v59
    v_exp_f32 v60, v60
    v_exp_f32 v61, v61
    v_exp_f32 v62, v62
    v_exp_f32 v63, v63
L_T55_22:
L_P_T55:
    v_exp_f32 v32, v32
    v_exp_f32 v33, v33
    v_smfmac_f32_32x32x32_bf16 v[80:95], v[20:23], v[56:63], v64
    s_waitcnt lgkmcnt(1)
    ds_read_b128 v[20:23], v4 offset:45408
    v_exp_f32 v34, v34
    v_exp_f32 v35, v35
    v_exp_f32 v36, v36
    v_exp_f32 v37, v37
    v_mfma_f32_32x32x16_bf16 v[48:63], v[12:15], v[8:11], 0
    s_waitcnt lgkmcnt(1)
    ds_read_b128 v[12:15], v5 offset:49536
    v_exp_f32 v38, v38
    v_exp_f32 v39, v39
    v_exp_f32 v40, v40
    v_exp_f32 v41, v41
    v_exp_f32 v42, v42
    v_smfmac_f32_32x32x32_bf16 v[80:95], v[16:19], v[32:39], v64
    s_waitcnt lgkmcnt(1)
    ds_read_b128 v[16:19], v3 offset:47472
    v_exp_f32 v43, v43
    v_exp_f32 v44, v44
    v_exp_f32 v45, v45
    v_exp_f32 v46, v46
    v_exp_f32 v47, v47
L_T56_23:
L_P_T56:
    s_setprio 0
    v_exp_f32 v48, v48
    v_exp_f32 v49, v49
    v_smfmac_f32_32x32x32_bf16 v[80:95], v[20:23], v[40:47], v64
    s_waitcnt lgkmcnt(1)
    ds_read_b128 v[20:23], v4 offset:47472
    v_exp_f32 v50, v50
    v_exp_f32 v51, v51
    v_exp_f32 v52, v52
    v_exp_f32 v53, v53
    v_mfma_f32_32x32x16_bf16 v[32:47], v[12:15], v[8:11], 0
    s_waitcnt lgkmcnt(1)
    ds_read_b128 v[12:15], v5 offset:51600
    v_exp_f32 v54, v54
    v_exp_f32 v55, v55
    v_exp_f32 v56, v56
    v_exp_f32 v57, v57
    v_exp_f32 v58, v58
    v_smfmac_f32_32x32x32_bf16 v[80:95], v[16:19], v[48:55], v64
    s_waitcnt lgkmcnt(1)
    ds_read_b128 v[16:19], v3 offset:49536
    v_exp_f32 v59, v59
    v_exp_f32 v60, v60
    v_exp_f32 v61, v61
    v_exp_f32 v62, v62
    v_exp_f32 v63, v63
    v_add_u32 v5, 49536, v5
    v_add_u32 v3, 49536, v3
    v_add_u32 v4, 49536, v4
L_T57_24:
L_P_T57:
    s_cmp_lt_u32 s44, 8
    s_cbranch_scc1 L_slow2
L_slow2_ret:
    s_waitcnt vmcnt(0)
    s_barrier
    s_setprio 3
    v_exp_f32 v32, v32
    v_exp_f32 v33, v33
    v_smfmac_f32_32x32x32_bf16 v[80:95], v[20:23], v[56:63], v64
    s_waitcnt lgkmcnt(1)
    ds_read_b128 v[20:23], v4 offset:0
    v_exp_f32 v34, v34
    v_exp_f32 v35, v35
    v_exp_f32 v36, v36
    v_exp_f32 v37, v37
    v_mfma_f32_32x32x16_bf16 v[48:63], v[12:15], v[8:11], 0
    s_waitcnt lgkmcnt(1)
    ds_read_b128 v[12:15], v5 offset:4128
    v_exp_f32 v38, v38
    v_exp_f32 v39, v39
    v_exp_f32 v40, v40
    v_exp_f32 v41, v41
    v_exp_f32 v42, v42
    v_smfmac_f32_32x32x32_bf16 v[80:95], v[16:19], v[32:39], v64
    s_waitcnt lgkmcnt(1)
    ds_read_b128 v[16:19], v3 offset:2064
    v_exp_f32 v43, v43
    v_exp_f32 v44, v44
    v_exp_f32 v45, v45
    v_exp_f32 v46, v46
    v_exp_f32 v47, v47
L_T58_25:
L_P_T58:
    v_exp_f32 v48, v48
    v_exp_f32 v49, v49
    v_smfmac_f32_32x32x32_bf16 v[80:95], v[20:23], v[40:47], v64
    s_waitcnt lgkmcnt(1)
    ds_read_b128 v[20:23], v4 offset:2064
    v_exp_f32 v50, v50
    v_exp_f32 v51, v51
    v_exp_f32 v52, v52
    v_exp_f32 v53, v53
    v_mfma_f32_32x32x16_bf16 v[32:47], v[12:15], v[8:11], 0
    s_waitcnt lgkmcnt(1)
    ds_read_b128 v[12:15], v5 offset:6192
    v_exp_f32 v54, v54
    v_exp_f32 v55, v55
    v_exp_f32 v56, v56
    v_exp_f32 v57, v57
    v_exp_f32 v58, v58
    v_smfmac_f32_32x32x32_bf16 v[80:95], v[16:19], v[48:55], v64
    s_waitcnt lgkmcnt(1)
    ds_read_b128 v[16:19], v3 offset:4128
    v_exp_f32 v59, v59
    v_exp_f32 v60, v60
    v_exp_f32 v61, v61
    v_exp_f32 v62, v62
    v_exp_f32 v63, v63
L_T59_26:
L_P_T59:
    v_exp_f32 v32, v32
    v_exp_f32 v33, v33
    v_smfmac_f32_32x32x32_bf16 v[80:95], v[20:23], v[56:63], v64
    s_waitcnt lgkmcnt(1)
    ds_read_b128 v[20:23], v4 offset:4128
    v_exp_f32 v34, v34
    v_exp_f32 v35, v35
    v_exp_f32 v36, v36
    v_exp_f32 v37, v37
    v_mfma_f32_32x32x16_bf16 v[48:63], v[12:15], v[8:11], 0
    s_waitcnt lgkmcnt(1)
    ds_read_b128 v[12:15], v5 offset:8256
    buffer_load_dword v142, v141, s[12:15], 0 offen sc1
    v_exp_f32 v38, v38
    v_exp_f32 v39, v39
    v_exp_f32 v40, v40
    v_exp_f32 v41, v41
    v_exp_f32 v42, v42
    v_smfmac_f32_32x32x32_bf16 v[80:95], v[16:19], v[32:39], v64
    s_waitcnt lgkmcnt(1)
    ds_read_b128 v[16:19], v3 offset:6192
    v_exp_f32 v43, v43
    v_exp_f32 v44, v44
    v_exp_f32 v45, v45
    v_exp_f32 v46, v46
    v_exp_f32 v47, v47
L_T60_27:
L_P_T60:
    v_exp_f32 v48, v48
    v_exp_f32 v49, v49
    v_smfmac_f32_32x32x32_bf16 v[80:95], v[20:23], v[40:47], v64
    s_waitcnt lgkmcnt(1)
    ds_read_b128 v[20:23], v4 offset:6192
    v_exp_f32 v50, v50
    v_exp_f32 v51, v51
    v_exp_f32 v52, v52
    v_exp_f32 v53, v53
    v_mfma_f32_32x32x16_bf16 v[32:47], v[12:15], v[8:11], 0
    s_waitcnt lgkmcnt(1)
    ds_read_b128 v[12:15], v5 offset:10320
    v_exp_f32 v54, v54
    v_exp_f32 v55, v55
    v_exp_f32 v56, v56
    v_exp_f32 v57, v57
    v_exp_f32 v58, v58
    v_smfmac_f32_32x32x32_bf16 v[80:95], v[16:19], v[48:55], v64
    s_waitcnt lgkmcnt(1)
    ds_read_b128 v[16:19], v3 offset:8256
    v_exp_f32 v59, v59
    v_exp_f32 v60, v60
    v_exp_f32 v61, v61
    v_exp_f32 v62, v62
    v_exp_f32 v63, v63
L_T61_28:
L_P_T61:
    v_exp_f32 v32, v32
    v_exp_f32 v33, v33
    v_smfmac_f32_32x32x32_bf16 v[80:95], v[20:23], v[56:63], v64
    s_waitcnt lgkmcnt(1)
    ds_read_b128 v[20:23], v4 offset:8256
    v_exp_f32 v34, v34
    v_exp_f32 v35, v35
    v_exp_f32 v36, v36
    v_exp_f32 v37, v37
    v_mfma_f32_32x32x16_bf16 v[48:63], v[12:15], v[8:11], 0
    s_waitcnt lgkmcnt(1)
    ds_read_b128 v[12:15], v5 offset:12384
    v_exp_f32 v38, v38
    v_exp_f32 v39, v39
    v_exp_f32 v40, v40
    v_exp_f32 v41, v41
    v_exp_f32 v42, v42
    v_smfmac_f32_32x32x32_bf16 v[80:95], v[16:19], v[32:39], v64
    s_waitcnt lgkmcnt(1)
    ds_read_b128 v[16:19], v3 offset:10320
    v_exp_f32 v43, v43
    v_exp_f32 v44, v44
    v_exp_f32 v45, v45
    v_exp_f32 v46, v46
    v_exp_f32 v47, v47
L_T62_29:
L_P_T62:
    v_exp_f32 v48, v48
    v_exp_f32 v49, v49
    v_smfmac_f32_32x32x32_bf16 v[80:95], v[20:23], v[40:47], v64
    s_waitcnt lgkmcnt(1)
    ds_read_b128 v[20:23], v4 offset:10320
    v_exp_f32 v50, v50
    v_exp_f32 v51, v51
    v_exp_f32 v52, v52
    v_exp_f32 v53, v53
    v_mfma_f32_32x32x16_bf16 v[32:47], v[12:15], v[8:11], 0
    s_waitcnt lgkmcnt(1)
    ds_read_b128 v[12:15], v5 offset:14448
    v_exp_f32 v54, v54
    v_exp_f32 v55, v55
    v_exp_f32 v56, v56
    v_exp_f32 v57, v57
    v_exp_f32 v58, v58
    v_smfmac_f32_32x32x32_bf16 v[80:95], v[16:19], v[48:55], v64
    s_waitcnt lgkmcnt(1)
    ds_read_b128 v[16:19], v3 offset:12384
    v_exp_f32 v59, v59
    v_exp_f32 v60, v60
    v_exp_f32 v61, v61
    v_exp_f32 v62, v62
    v_exp_f32 v63, v63
L_T63_30:
L_P_T63:
    v_exp_f32 v32, v32
    v_exp_f32 v33, v33
    v_smfmac_f32_32x32x32_bf16 v[80:95], v[20:23], v[56:63], v64
    s_waitcnt lgkmcnt(1)
    ds_read_b128 v[20:23], v4 offset:12384
    v_exp_f32 v34, v34
    v_exp_f32 v35, v35
    v_exp_f32 v36, v36
    v_exp_f32 v37, v37
    v_mfma_f32_32x32x16_bf16 v[48:63], v[12:15], v[8:11], 0
    s_waitcnt lgkmcnt(1)
    ds_read_b128 v[12:15], v5 offset:16512
    v_exp_f32 v38, v38
    v_exp_f32 v39, v39
    v_exp_f32 v40, v40
    v_exp_f32 v41, v41
    v_exp_f32 v42, v42
    v_smfmac_f32_32x32x32_bf16 v[80:95], v[16:19], v[32:39], v64
    s_waitcnt lgkmcnt(1)
    ds_read_b128 v[16:19], v3 offset:14448
    v_exp_f32 v43, v43
    v_exp_f32 v44, v44
    v_exp_f32 v45, v45
    v_exp_f32 v46, v46
    v_exp_f32 v47, v47
L_T64_31:
L_P_T64:
    v_exp_f32 v48, v48
    v_exp_f32 v49, v49
    v_smfmac_f32_32x32x32_bf16 v[80:95], v[20:23], v[40:47], v64
    s_waitcnt lgkmcnt(1)
    ds_read_b128 v[20:23], v4 offset:14448
    v_exp_f32 v50, v50
    v_exp_f32 v51, v51
    v_exp_f32 v52, v52
    v_exp_f32 v53, v53
    v_mfma_f32_32x32x16_bf16 v[32:47], v[12:15], v[8:11], 0
    s_waitcnt lgkmcnt(1)
    ds_read_b128 v[12:15], v5 offset:18576
    v_exp_f32 v54, v54
    v_exp_f32 v55, v55
    v_exp_f32 v56, v56
    v_exp_f32 v57, v57
    v_exp_f32 v58, v58
    v_smfmac_f32_32x32x32_bf16 v[80:95], v[16:19], v[48:55], v64
    s_waitcnt lgkmcnt(1)
    ds_read_b128 v[16:19], v3 offset:16512
    v_exp_f32 v59, v59
    v_exp_f32 v60, v60
    v_exp_f32 v61, v61
    v_exp_f32 v62, v62
    v_exp_f32 v63, v63
    s_waitcnt vmcnt(0)
L_common:
L_T65_32:
L_P_T65:
    v_cmp_gt_u32 vcc, 2, v142
    s_nop 0
    s_and_b32 s75, vcc_hi, 0xff00ff00
    s_or_b32 s75, s75, vcc_lo
    s_cbranch_scc1 L_c1
L_c1_ret:
    s_setprio 2
    v_exp_f32 v32, v32
    v_exp_f32 v33, v33
    v_smfmac_f32_32x32x32_bf16 v[80:95], v[20:23], v[56:63], v64
    s_waitcnt lgkmcnt(1)
    ds_read_b128 v[20:23], v4 offset:16512
    s_add_u32 s76, s70, 0
    s_add_u32 s77, s71, 0
    buffer_load_dwordx4 v[176:179], v7, s[12:15], s76 offen offset:0 sc1
    v_exp_f32 v34, v34
    v_exp_f32 v35, v35
    v_exp_f32 v36, v36
    v_exp_f32 v37, v37
    v_mfma_f32_32x32x16_bf16 v[48:63], v[12:15], v[8:11], 0
    s_waitcnt lgkmcnt(1)
    ds_read_b128 v[12:15], v5 offset:20640
    v_exp_f32 v38, v38
    v_exp_f32 v39, v39
    v_exp_f32 v40, v40
    v_exp_f32 v41, v41
    v_exp_f32 v42, v42
    v_smfmac_f32_32x32x32_bf16 v[80:95], v[16:19], v[32:39], v64
    s_waitcnt lgkmcnt(1)
    ds_read_b128 v[16:19], v3 offset:18576
    buffer_load_dwordx4 v[208:211], v7, s[12:15], s77 offen offset:0 sc1
    v_exp_f32 v43, v43
    v_exp_f32 v44, v44
    v_exp_f32 v45, v45
    v_exp_f32 v46, v46
    v_exp_f32 v47, v47
L_T66_33:
L_P_T66:
    v_exp_f32 v48, v48
    v_exp_f32 v49, v49
    v_smfmac_f32_32x32x32_bf16 v[80:95], v[20:23], v[40:47], v64
    s_waitcnt lgkmcnt(1)
    ds_read_b128 v[20:23], v4 offset:18576
    v_exp_f32 v50, v50
    v_exp_f32 v51, v51
    v_exp_f32 v52, v52
    v_exp_f32 v53, v53
    v_mfma_f32_32x32x16_bf16 v[32:47], v[12:15], v[8:11], 0
    s_waitcnt lgkmcnt(1)
    ds_read_b128 v[12:15], v5 offset:22704
    buffer_load_dwordx4 v[180:183], v7, s[12:15], s76 offen offset:1024 sc1
    v_exp_f32 v54, v54
    v_exp_f32 v55, v55
    v_exp_f32 v56, v56
    v_exp_f32 v57, v57
    v_exp_f32 v58, v58
    v_smfmac_f32_32x32x32_bf16 v[80:95], v[16:19], v[48:55], v64
    s_waitcnt lgkmcnt(1)
    ds_read_b128 v[16:19], v3 offset:20640
    v_exp_f32 v59, v59
    v_exp_f32 v60, v60
    v_exp_f32 v61, v61
    v_exp_f32 v62, v62
    v_exp_f32 v63, v63
L_T67_34:
L_P_T67:
    v_exp_f32 v32, v32
    v_exp_f32 v33, v33
    v_smfmac_f32_32x32x32_bf16 v[80:95], v[20:23], v[56:63], v64
    s_waitcnt lgkmcnt(1)
    ds_read_b128 v[20:23], v4 offset:20640
    buffer_load_dwordx4 v[212:215], v7, s[12:15], s77 offen offset:1024 sc1
    v_exp_f32 v34, v34
    v_exp_f32 v35, v35
    v_exp_f32 v36, v36
    v_exp_f32 v37, v37
    v_mfma_f32_32x32x16_bf16 v[48:63], v[12:15], v[8:11], 0
    s_waitcnt lgkmcnt(1)
    ds_read_b128 v[12:15], v5 offset:24768
    v_exp_f32 v38, v38
    v_exp_f32 v39, v39
    v_exp_f32 v40, v40
    v_exp_f32 v41, v41
    v_exp_f32 v42, v42
    v_smfmac_f32_32x32x32_bf16 v[80:95], v[16:19], v[32:39], v64
    s_waitcnt lgkmcnt(1)
    ds_read_b128 v[16:19], v3 offset:22704
    v_exp_f32 v43, v43
    v_exp_f32 v44, v44
    v_exp_f32 v45, v45
    v_exp_f32 v46, v46
    v_exp_f32 v47, v47
L_T68_35:
L_P_T68:
    v_exp_f32 v48, v48
    v_exp_f32 v49, v49
    v_smfmac_f32_32x32x32_bf16 v[80:95], v[20:23], v[40:47], v64
    s_waitcnt lgkmcnt(1)
    ds_read_b128 v[20:23], v4 offset:22704
    buffer_load_dwordx4 v[184:187], v7, s[12:15], s76 offen offset:2048 sc1
    v_exp_f32 v50, v50
    v_exp_f32 v51, v51
    v_exp_f32 v52, v52
    v_exp_f32 v53, v53
    v_mfma_f32_32x32x16_bf16 v[32:47], v[12:15], v[8:11], 0
    s_waitcnt lgkmcnt(1)
    ds_read_b128 v[12:15], v5 offset:26832
    v_exp_f32 v54, v54
    v_exp_f32 v55, v55
    v_exp_f32 v56, v56
    v_exp_f32 v57, v57
    v_exp_f32 v58, v58
    v_smfmac_f32_32x32x32_bf16 v[80:95], v[16:19], v[48:55], v64
    s_waitcnt lgkmcnt(1)
    ds_read_b128 v[16:19], v3 offset:24768
    buffer_load_dwordx4 v[216:219], v7, s[12:15], s77 offen offset:2048 sc1
    v_exp_f32 v59, v59
    v_exp_f32 v60, v60
    v_exp_f32 v61, v61
    v_exp_f32 v62, v62
    v_exp_f32 v63, v63
L_T69_36:
L_P_T69:
    v_exp_f32 v32, v32
    v_exp_f32 v33, v33
    v_smfmac_f32_32x32x32_bf16 v[80:95], v[20:23], v[56:63], v64
    s_waitcnt lgkmcnt(1)
    ds_read_b128 v[20:23], v4 offset:24768
    v_exp_f32 v34, v34
    v_exp_f32 v35, v35
    v_exp_f32 v36, v36
    v_exp_f32 v37, v37
    v_mfma_f32_32x32x16_bf16 v[48:63], v[12:15], v[8:11], 0
    s_waitcnt lgkmcnt(1)
    ds_read_b128 v[12:15], v5 offset:28896
    buffer_load_dwordx4 v[188:191], v7, s[12:15], s76 offen offset:3072 sc1
    v_exp_f32 v38, v38
    v_exp_f32 v39, v39
    v_exp_f32 v40, v40
    v_exp_f32 v41, v41
    v_exp_f32 v42, v42
    v_smfmac_f32_32x32x32_bf16 v[80:95], v[16:19], v[32:39], v64
    s_waitcnt lgkmcnt(1)
    ds_read_b128 v[16:19], v3 offset:26832
    v_exp_f32 v43, v43
    v_exp_f32 v44, v44
    v_exp_f32 v45, v45
    v_exp_f32 v46, v46
    v_exp_f32 v47, v47
L_T70_37:
L_P_T70:
    v_exp_f32 v48, v48
    v_exp_f32 v49, v49
    v_smfmac_f32_32x32x32_bf16 v[80:95], v[20:23], v[40:47], v64
    s_waitcnt lgkmcnt(1)
    ds_read_b128 v[20:23], v4 offset:26832
    buffer_load_dwordx4 v[220:223], v7, s[12:15], s77 offen offset:3072 sc1
    v_exp_f32 v50, v50
    v_exp_f32 v51, v51
    v_exp_f32 v52, v52
    v_exp_f32 v53, v53
    v_mfma_f32_32x32x16_bf16 v[32:47], v[12:15], v[8:11], 0
    s_waitcnt lgkmcnt(1)
    ds_read_b128 v[12:15], v5 offset:30960
    v_exp_f32 v54, v54
    v_exp_f32 v55, v55
    v_exp_f32 v56, v56
    v_exp_f32 v57, v57
    v_exp_f32 v58, v58
    v_smfmac_f32_32x32x32_bf16 v[80:95], v[16:19], v[48:55], v64
    s_waitcnt lgkmcnt(1)
    ds_read_b128 v[16:19], v3 offset:28896
    v_exp_f32 v59, v59
    v_exp_f32 v60, v60
    v_exp_f32 v61, v61
    v_exp_f32 v62, v62
    v_exp_f32 v63, v63
L_T71_38:
L_P_T71:
    v_exp_f32 v32, v32
    v_exp_f32 v33, v33
    v_smfmac_f32_32x32x32_bf16 v[80:95], v[20:23], v[56:63], v64
    s_waitcnt lgkmcnt(1)
    ds_read_b128 v[20:23], v4 offset:28896
    s_add_u32 s76, s70, 4096
    s_add_u32 s77, s71, 4096
    buffer_load_dwordx4 v[192:195], v7, s[12:15], s76 offen offset:0 sc1
    v_exp_f32 v34, v34
    v_exp_f32 v35, v35
    v_exp_f32 v36, v36
    v_exp_f32 v37, v37
    v_mfma_f32_32x32x16_bf16 v[48:63], v[12:15], v[8:11], 0
    s_waitcnt lgkmcnt(1)
    ds_read_b128 v[12:15], v5 offset:33024
    v_exp_f32 v38, v38
    v_exp_f32 v39, v39
    v_exp_f32 v40, v40
    v_exp_f32 v41, v41
    v_exp_f32 v42, v42
    v_smfmac_f32_32x32x32_bf16 v[80:95], v[16:19], v[32:39], v64
    s_waitcnt lgkmcnt(1)
    ds_read_b128 v[16:19], v3 offset:30960
    buffer_load_dwordx4 v[224:227], v7, s[12:15], s77 offen offset:0 sc1
    v_exp_f32 v43, v43
    v_exp_f32 v44, v44
    v_exp_f32 v45, v45
    v_exp_f32 v46, v46
    v_exp_f32 v47, v47
L_T72_39:
L_P_T72:
    v_exp_f32 v48, v48
    v_exp_f32 v49, v49
    v_smfmac_f32_32x32x32_bf16 v[80:95], v[20:23], v[40:47], v64
    s_waitcnt lgkmcnt(1)
    ds_read_b128 v[20:23], v4 offset:30960
    v_exp_f32 v50, v50
    v_exp_f32 v51, v51
    v_exp_f32 v52, v52
    v_exp_f32 v53, v53
    v_mfma_f32_32x32x16_bf16 v[32:47], v[12:15], v[8:11], 0
    s_waitcnt lgkmcnt(1)
    ds_read_b128 v[12:15], v5 offset:35088
    buffer_load_dwordx4 v[196:199], v7, s[12:15], s76 offen offset:1024 sc1
    v_exp_f32 v54, v54
    v_exp_f32 v55, v55
    v_exp_f32 v56, v56
    v_exp_f32 v57, v57
    v_exp_f32 v58, v58
    v_smfmac_f32_32x32x32_bf16 v[80:95], v[16:19], v[48:55], v64
    s_waitcnt lgkmcnt(1)
    ds_read_b128 v[16:19], v3 offset:33024
    v_exp_f32 v59, v59
    v_exp_f32 v60, v60
    v_exp_f32 v61, v61
    v_exp_f32 v62, v62
    v_exp_f32 v63, v63
L_T73_40:
L_P_T73:
    v_exp_f32 v32, v32
    v_exp_f32 v33, v33
    v_smfmac_f32_32x32x32_bf16 v[80:95], v[20:23], v[56:63], v64
    s_waitcnt lgkmcnt(1)
    ds_read_b128 v[20:23], v4 offset:33024
    buffer_load_dwordx4 v[228:231], v7, s[12:15], s77 offen offset:1024 sc1
    v_exp_f32 v34, v34
    v_exp_f32 v35, v35
    v_exp_f32 v36, v36
    v_exp_f32 v37, v37
    v_mfma_f32_32x32x16_bf16 v[48:63], v[12:15], v[8:11], 0
    s_waitcnt lgkmcnt(1)
    ds_read_b128 v[12:15], v5 offset:37152
    v_exp_f32 v38, v38
    v_exp_f32 v39, v39
    v_exp_f32 v40, v40
    v_exp_f32 v41, v41
    v_exp_f32 v42, v42
    v_smfmac_f32_32x32x32_bf16 v[80:95], v[16:19], v[32:39], v64
    s_waitcnt lgkmcnt(1)
    ds_read_b128 v[16:19], v3 offset:35088
    buffer_load_dword v143, v141, s[12:15], 0 offen sc1
    v_exp_f32 v43, v43
    v_exp_f32 v44, v44
    v_exp_f32 v45, v45
    v_exp_f32 v46, v46
    v_exp_f32 v47, v47
L_T74_41:
L_P_T74:
    v_exp_f32 v48, v48
    v_exp_f32 v49, v49
    v_smfmac_f32_32x32x32_bf16 v[80:95], v[20:23], v[40:47], v64
    s_waitcnt lgkmcnt(1)
    ds_read_b128 v[20:23], v4 offset:35088
    buffer_load_dwordx4 v[200:203], v7, s[12:15], s76 offen offset:2048 sc1
    v_exp_f32 v50, v50
    v_exp_f32 v51, v51
    v_exp_f32 v52, v52
    v_exp_f32 v53, v53
    v_mfma_f32_32x32x16_bf16 v[32:47], v[12:15], v[8:11], 0
    s_waitcnt lgkmcnt(1)
    ds_read_b128 v[12:15], v5 offset:39216
    v_exp_f32 v54, v54
    v_exp_f32 v55, v55
    v_exp_f32 v56, v56
    v_exp_f32 v57, v57
    v_exp_f32 v58, v58
    v_smfmac_f32_32x32x32_bf16 v[80:95], v[16:19], v[48:55], v64
    s_waitcnt lgkmcnt(1)
    ds_read_b128 v[16:19], v3 offset:37152
    buffer_load_dwordx4 v[232:235], v7, s[12:15], s77 offen offset:2048 sc1
    v_exp_f32 v59, v59
    v_exp_f32 v60, v60
    v_exp_f32 v61, v61
    v_exp_f32 v62, v62
    v_exp_f32 v63, v63
L_T75_42:
L_P_T75:
    v_exp_f32 v32, v32
    v_exp_f32 v33, v33
    v_smfmac_f32_32x32x32_bf16 v[80:95], v[20:23], v[56:63], v64
    s_waitcnt lgkmcnt(1)
    ds_read_b128 v[20:23], v4 offset:37152
    v_exp_f32 v34, v34
    v_exp_f32 v35, v35
    v_exp_f32 v36, v36
    v_exp_f32 v37, v37
    v_mfma_f32_32x32x16_bf16 v[48:63], v[12:15], v[8:11], 0
    s_waitcnt lgkmcnt(1)
    ds_read_b128 v[12:15], v5 offset:41280
    buffer_load_dwordx4 v[204:207], v7, s[12:15], s76 offen offset:3072 sc1
    v_exp_f32 v38, v38
    v_exp_f32 v39, v39
    v_exp_f32 v40, v40
    v_exp_f32 v41, v41
    v_exp_f32 v42, v42
    v_smfmac_f32_32x32x32_bf16 v[80:95], v[16:19], v[32:39], v64
    s_waitcnt lgkmcnt(1)
    ds_read_b128 v[16:19], v3 offset:39216
    v_exp_f32 v43, v43
    v_exp_f32 v44, v44
    v_exp_f32 v45, v45
    v_exp_f32 v46, v46
    v_exp_f32 v47, v47
L_T76_43:
L_P_T76:
    v_exp_f32 v48, v48
    v_exp_f32 v49, v49
    v_smfmac_f32_32x32x32_bf16 v[80:95], v[20:23], v[40:47], v64
    s_waitcnt lgkmcnt(1)
    ds_read_b128 v[20:23], v4 offset:39216
    buffer_load_dwordx4 v[236:239], v7, s[12:15], s77 offen offset:3072 sc1
    v_exp_f32 v50, v50
    v_exp_f32 v51, v51
    v_exp_f32 v52, v52
    v_exp_f32 v53, v53
    v_mfma_f32_32x32x16_bf16 v[32:47], v[12:15], v[8:11], 0
    s_waitcnt lgkmcnt(1)
    ds_read_b128 v[12:15], v5 offset:43344
    v_exp_f32 v54, v54
    v_exp_f32 v55, v55
    v_exp_f32 v56, v56
    v_exp_f32 v57, v57
    v_exp_f32 v58, v58
    v_smfmac_f32_32x32x32_bf16 v[80:95], v[16:19], v[48:55], v64
    s_waitcnt lgkmcnt(1)
    ds_read_b128 v[16:19], v3 offset:41280
    v_exp_f32 v59, v59
    v_exp_f32 v60, v60
    v_exp_f32 v61, v61
    v_exp_f32 v62, v62
    v_exp_f32 v63, v63
L_T77_44:
L_P_T77:
    s_waitcnt vmcnt(4)
    v_cmp_ne_u32 vcc, 3, v143
    v_and_b32 v24, 31, v1
    s_and_b32 s75, vcc_hi, 0x00ff00ff
    s_cbranch_scc1 L_c2
L_c2_ret:
    v_lshlrev_b32 v24, 2, v24
    buffer_load_dword v137, v24, s[12:15], s74 offen sc1
    s_add_u32 s30, s72, 10485760
    s_add_u32 s31, s72, 10489856
    v_exp_f32 v32, v32
    v_exp_f32 v33, v33
    v_smfmac_f32_32x32x32_bf16 v[80:95], v[20:23], v[56:63], v64
    s_waitcnt lgkmcnt(1)
    ds_read_b128 v[20:23], v4 offset:41280
    buffer_load_dwordx4 v[112:115], v2, s[12:15], s30 offen offset:0 sc1
    v_exp_f32 v34, v34
    v_exp_f32 v35, v35
    v_exp_f32 v36, v36
    v_exp_f32 v37, v37
    v_mfma_f32_32x32x16_bf16 v[48:63], v[12:15], v[8:11], 0
    s_waitcnt lgkmcnt(1)
    ds_read_b128 v[12:15], v5 offset:45408
    v_exp_f32 v38, v38
    v_exp_f32 v39, v39
    v_exp_f32 v40, v40
    v_exp_f32 v41, v41
    v_exp_f32 v42, v42
    v_smfmac_f32_32x32x32_bf16 v[80:95], v[16:19], v[32:39], v64
    s_waitcnt lgkmcnt(1)
    ds_read_b128 v[16:19], v3 offset:43344
    buffer_load_dwordx4 v[116:119], v2, s[12:15], s30 offen offset:1024 sc1
    v_exp_f32 v43, v43
    v_exp_f32 v44, v44
    v_exp_f32 v45, v45
    v_exp_f32 v46, v46
    v_exp_f32 v47, v47
L_T78_45:
L_P_T78:
    v_exp_f32 v48, v48
    v_exp_f32 v49, v49
    v_smfmac_f32_32x32x32_bf16 v[80:95], v[20:23], v[40:47], v64
    s_waitcnt lgkmcnt(1)
    ds_read_b128 v[20:23], v4 offset:43344
    v_exp_f32 v50, v50
    v_exp_f32 v51, v51
    v_exp_f32 v52, v52
    v_exp_f32 v53, v53
    v_mfma_f32_32x32x16_bf16 v[32:47], v[12:15], v[8:11], 0
    s_waitcnt lgkmcnt(1)
    ds_read_b128 v[12:15], v5 offset:47472
    buffer_load_dwordx4 v[120:123], v2, s[12:15], s30 offen offset:2048 sc1
    v_exp_f32 v54, v54
    v_exp_f32 v55, v55
    v_exp_f32 v56, v56
    v_exp_f32 v57, v57
    v_exp_f32 v58, v58
    v_smfmac_f32_32x32x32_bf16 v[80:95], v[16:19], v[48:55], v64
    s_waitcnt lgkmcnt(1)
    ds_read_b128 v[16:19], v3 offset:45408
    v_exp_f32 v59, v59
    v_exp_f32 v60, v60
    v_exp_f32 v61, v61
    v_exp_f32 v62, v62
    v_exp_f32 v63, v63
L_T79_46:
L_P_T79:
    v_exp_f32 v32, v32
    v_exp_f32 v33, v33
    v_smfmac_f32_32x32x32_bf16 v[80:95], v[20:23], v[56:63], v64
    s_waitcnt lgkmcnt(1)
    ds_read_b128 v[20:23], v4 offset:45408
    buffer_load_dwordx4 v[124:127], v2, s[12:15], s30 offen offset:3072 sc1
    v_exp_f32 v34, v34
    v_exp_f32 v35, v35
    v_exp_f32 v36, v36
    v_exp_f32 v37, v37
    v_mfma_f32_32x32x16_bf16 v[48:63], v[12:15], v[8:11], 0
    s_waitcnt lgkmcnt(1)
    ds_read_b128 v[12:15], v5 offset:49536
    v_exp_f32 v38, v38
    v_exp_f32 v39, v39
    v_exp_f32 v40, v40
    v_exp_f32 v41, v41
    v_exp_f32 v42, v42
    v_smfmac_f32_32x32x32_bf16 v[80:95], v[16:19], v[32:39], v64
    s_waitcnt lgkmcnt(1)
    ds_read_b128 v[16:19], v3 offset:47472
    v_exp_f32 v43, v43
    v_exp_f32 v44, v44
    v_exp_f32 v45, v45
    v_exp_f32 v46, v46
    v_exp_f32 v47, v47
L_T80_47:
L_P_T80:
    v_exp_f32 v48, v48
    v_exp_f32 v49, v49
    v_smfmac_f32_32x32x32_bf16 v[80:95], v[20:23], v[40:47], v64
    s_waitcnt lgkmcnt(1)
    ds_read_b128 v[20:23], v4 offset:47472
    buffer_load_dwordx4 v[128:131], v2, s[12:15], s31 offen offset:0 sc1
    v_exp_f32 v50, v50
    v_exp_f32 v51, v51
    v_exp_f32 v52, v52
    v_exp_f32 v53, v53
    v_mfma_f32_32x32x16_bf16 v[32:47], v[12:15], v[8:11], 0
    s_waitcnt lgkmcnt(1)
    ds_read_b128 v[12:15], v5 offset:51600
    v_exp_f32 v54, v54
    v_exp_f32 v55, v55
    v_exp_f32 v56, v56
    v_exp_f32 v57, v57
    v_exp_f32 v58, v58
    v_smfmac_f32_32x32x32_bf16 v[80:95], v[16:19], v[48:55], v64
    s_waitcnt lgkmcnt(1)
    ds_read_b128 v[16:19], v3 offset:49536
    buffer_load_dwordx4 v[132:135], v2, s[12:15], s31 offen offset:1024 sc1
    v_exp_f32 v59, v59
    v_exp_f32 v60, v60
    v_exp_f32 v61, v61
    v_exp_f32 v62, v62
    v_exp_f32 v63, v63
    v_add_u32 v5, 49536, v5
    v_add_u32 v3, 49536, v3
    v_add_u32 v4, 49536, v4
L_T81_48:
L_P_T81:
    s_setprio 1
    v_exp_f32 v32, v32
    v_exp_f32 v33, v33
    v_smfmac_f32_32x32x32_bf16 v[80:95], v[20:23], v[56:63], v64
    s_waitcnt lgkmcnt(1)
    ds_read_b128 v[20:23], v4 offset:0
    v_exp_f32 v34, v34
    v_exp_f32 v35, v35
    v_exp_f32 v36, v36
    v_exp_f32 v37, v37
    v_mfma_f32_32x32x16_bf16 v[48:63], v[12:15], v[8:11], 0
    s_waitcnt lgkmcnt(1)
    ds_read_b128 v[12:15], v5 offset:4128
    buffer_load_dwordx4 v[240:243], v2, s[12:15], s31 offen offset:2048 sc1
    s_waitcnt vmcnt(6)
    v_mfma_f32_32x32x16_bf16 v[144:159], v[176:179], v[112:115], 0
    s_add_u32 s76, s70, 524288
    s_add_u32 s77, s71, 524288
    buffer_load_dwordx4 v[176:179], v7, s[12:15], s76 offen offset:0 sc1
    v_exp_f32 v38, v38
    v_exp_f32 v39, v39
    v_exp_f32 v40, v40
    v_exp_f32 v41, v41
    v_exp_f32 v42, v42
    v_smfmac_f32_32x32x32_bf16 v[80:95], v[16:19], v[32:39], v64
    s_waitcnt lgkmcnt(1)
    ds_read_b128 v[16:19], v3 offset:2064
    v_mfma_f32_32x32x16_bf16 v[160:175], v[208:211], v[112:115], 0
    buffer_load_dwordx4 v[208:211], v7, s[12:15], s77 offen offset:0 sc1
    v_exp_f32 v43, v43
    v_exp_f32 v44, v44
    v_exp_f32 v45, v45
    v_exp_f32 v46, v46
    v_exp_f32 v47, v47
L_T82_49:
L_P_T82:
    v_exp_f32 v48, v48
    v_exp_f32 v49, v49
    v_smfmac_f32_32x32x32_bf16 v[80:95], v[20:23], v[40:47], v64
    s_waitcnt lgkmcnt(1)
    ds_read_b128 v[20:23], v4 offset:2064
    buffer_load_dwordx4 v[244:247], v2, s[12:15], s31 offen offset:3072 sc1
    v_exp_f32 v50, v50
    v_exp_f32 v51, v51
    v_exp_f32 v52, v52
    v_exp_f32 v53, v53
    v_mfma_f32_32x32x16_bf16 v[32:47], v[12:15], v[8:11], 0
    s_waitcnt lgkmcnt(1)
    ds_read_b128 v[12:15], v5 offset:6192
    s_waitcnt vmcnt(8)
    v_mfma_f32_32x32x16_bf16 v[144:159], v[180:183], v[116:119], v[144:159]
    buffer_load_dwordx4 v[180:183], v7, s[12:15], s76 offen offset:1024 sc1
    v_exp_f32 v54, v54
    v_exp_f32 v55, v55
    v_exp_f32 v56, v56
    v_exp_f32 v57, v57
    v_exp_f32 v58, v58
    v_smfmac_f32_32x32x32_bf16 v[80:95], v[16:19], v[48:55], v64
    s_waitcnt lgkmcnt(1)
    ds_read_b128 v[16:19], v3 offset:4128
    v_mfma_f32_32x32x16_bf16 v[160:175], v[212:215], v[116:119], v[160:175]
    buffer_load_dwordx4 v[212:215], v7, s[12:15], s77 offen offset:1024 sc1
    v_exp_f32 v59, v59
    v_exp_f32 v60, v60
    v_exp_f32 v61, v61
    v_exp_f32 v62, v62
    v_exp_f32 v63, v63
L_T83_50:
L_P_T83:
    v_exp_f32 v32, v32
    v_exp_f32 v33, v33
    v_smfmac_f32_32x32x32_bf16 v[80:95], v[20:23], v[56:63], v64
    s_waitcnt lgkmcnt(1)
    ds_read_b128 v[20:23], v4 offset:4128
    v_exp_f32 v34, v34
    v_exp_f32 v35, v35
    v_exp_f32 v36, v36
    v_exp_f32 v37, v37
    v_mfma_f32_32x32x16_bf16 v[48:63], v[12:15], v[8:11], 0
    s_waitcnt lgkmcnt(1)
    ds_read_b128 v[12:15], v5 offset:8256
    s_waitcnt vmcnt(9)
    v_mfma_f32_32x32x16_bf16 v[144:159], v[184:187], v[120:123], v[144:159]
    buffer_load_dwordx4 v[184:187], v7, s[12:15], s76 offen offset:2048 sc1
    v_exp_f32 v38, v38
    v_exp_f32 v39, v39
    v_exp_f32 v40, v40
    v_exp_f32 v41, v41
    v_exp_f32 v42, v42
    v_smfmac_f32_32x32x32_bf16 v[80:95], v[16:19], v[32:39], v64
    s_waitcnt lgkmcnt(1)
    ds_read_b128 v[16:19], v3 offset:6192
    v_mfma_f32_32x32x16_bf16 v[160:175], v[216:219], v[120:123], v[160:175]
    buffer_load_dwordx4 v[216:219], v7, s[12:15], s77 offen offset:2048 sc1
    v_exp_f32 v43, v43
    v_exp_f32 v44, v44
    v_exp_f32 v45, v45
    v_exp_f32 v46, v46
    v_exp_f32 v47, v47
L_T84_51:
L_P_T84:
    v_exp_f32 v48, v48
    v_exp_f32 v49, v49
    v_smfmac_f32_32x32x32_bf16 v[80:95], v[20:23], v[40:47], v64
    s_waitcnt lgkmcnt(1)
    ds_read_b128 v[20:23], v4 offset:6192
    v_exp_f32 v50, v50
    v_exp_f32 v51, v51
    v_exp_f32 v52, v52
    v_exp_f32 v53, v53
    v_mfma_f32_32x32x16_bf16 v[32:47], v[12:15], v[8:11], 0
    s_waitcnt lgkmcnt(1)
    ds_read_b128 v[12:15], v5 offset:10320
    s_waitcnt vmcnt(10)
    v_mfma_f32_32x32x16_bf16 v[144:159], v[188:191], v[124:127], v[144:159]
    buffer_load_dwordx4 v[188:191], v7, s[12:15], s76 offen offset:3072 sc1
    v_exp_f32 v54, v54
    v_exp_f32 v55, v55
    v_exp_f32 v56, v56
    v_exp_f32 v57, v57
    v_exp_f32 v58, v58
    v_smfmac_f32_32x32x32_bf16 v[80:95], v[16:19], v[48:55], v64
    s_waitcnt lgkmcnt(1)
    ds_read_b128 v[16:19], v3 offset:8256
    v_mfma_f32_32x32x16_bf16 v[160:175], v[220:223], v[124:127], v[160:175]
    buffer_load_dwordx4 v[220:223], v7, s[12:15], s77 offen offset:3072 sc1
    v_exp_f32 v59, v59
    v_exp_f32 v60, v60
    v_exp_f32 v61, v61
    v_exp_f32 v62, v62
    v_exp_f32 v63, v63
L_T85_52:
L_P_T85:
    v_exp_f32 v32, v32
    v_exp_f32 v33, v33
    v_smfmac_f32_32x32x32_bf16 v[80:95], v[20:23], v[56:63], v64
    s_waitcnt lgkmcnt(1)
    ds_read_b128 v[20:23], v4 offset:8256
    v_exp_f32 v34, v34
    v_exp_f32 v35, v35
    v_exp_f32 v36, v36
    v_exp_f32 v37, v37
    v_mfma_f32_32x32x16_bf16 v[48:63], v[12:15], v[8:11], 0
    s_waitcnt lgkmcnt(1)
    ds_read_b128 v[12:15], v5 offset:12384
    s_waitcnt vmcnt(11)
    v_mfma_f32_32x32x16_bf16 v[144:159], v[192:195], v[128:131], v[144:159]
    s_add_u32 s76, s70, 528384
    s_add_u32 s77, s71, 528384
    buffer_load_dwordx4 v[192:195], v7, s[12:15], s76 offen offset:0 sc1
    v_exp_f32 v38, v38
    v_exp_f32 v39, v39
    v_exp_f32 v40, v40
    v_exp_f32 v41, v41
    v_exp_f32 v42, v42
    v_smfmac_f32_32x32x32_bf16 v[80:95], v[16:19], v[32:39], v64
    s_waitcnt lgkmcnt(1)
    ds_read_b128 v[16:19], v3 offset:10320
    v_mfma_f32_32x32x16_bf16 v[160:175], v[224:227], v[128:131], v[160:175]
    buffer_load_dwordx4 v[224:227], v7, s[12:15], s77 offen offset:0 sc1
    v_exp_f32 v43, v43
    v_exp_f32 v44, v44
    v_exp_f32 v45, v45
    v_exp_f32 v46, v46
    v_exp_f32 v47, v47
L_T86_53:
L_P_T86:
    v_exp_f32 v48, v48
    v_exp_f32 v49, v49
    v_smfmac_f32_32x32x32_bf16 v[80:95], v[20:23], v[40:47], v64
    s_waitcnt lgkmcnt(1)
    ds_read_b128 v[20:23], v4 offset:10320
    v_exp_f32 v50, v50
    v_exp_f32 v51, v51
    v_exp_f32 v52, v52
    v_exp_f32 v53, v53
    v_mfma_f32_32x32x16_bf16 v[32:47], v[12:15], v[8:11], 0
    s_waitcnt lgkmcnt(1)
    ds_read_b128 v[12:15], v5 offset:14448
    s_waitcnt vmcnt(12)
    v_mfma_f32_32x32x16_bf16 v[144:159], v[196:199], v[132:135], v[144:159]
    buffer_load_dwordx4 v[196:199], v7, s[12:15], s76 offen offset:1024 sc1
    v_exp_f32 v54, v54
    v_exp_f32 v55, v55
    v_exp_f32 v56, v56
    v_exp_f32 v57, v57
    v_exp_f32 v58, v58
    v_smfmac_f32_32x32x32_bf16 v[80:95], v[16:19], v[48:55], v64
    s_waitcnt lgkmcnt(1)
    ds_read_b128 v[16:19], v3 offset:12384
    v_mfma_f32_32x32x16_bf16 v[160:175], v[228:231], v[132:135], v[160:175]
    buffer_load_dwordx4 v[228:231], v7, s[12:15], s77 offen offset:1024 sc1
    v_exp_f32 v59, v59
    v_exp_f32 v60, v60
    v_exp_f32 v61, v61
    v_exp_f32 v62, v62
    v_exp_f32 v63, v63
L_T87_54:
L_P_T87:
    v_exp_f32 v32, v32
    v_exp_f32 v33, v33
    v_smfmac_f32_32x32x32_bf16 v[80:95], v[20:23], v[56:63], v64
    s_waitcnt lgkmcnt(1)
    ds_read_b128 v[20:23], v4 offset:12384
    v_exp_f32 v34, v34
    v_exp_f32 v35, v35
    v_exp_f32 v36, v36
    v_exp_f32 v37, v37
    v_mfma_f32_32x32x16_bf16 v[48:63], v[12:15], v[8:11], 0
    s_waitcnt lgkmcnt(1)
    ds_read_b128 v[12:15], v5 offset:16512
    s_waitcnt vmcnt(13)
    v_mfma_f32_32x32x16_bf16 v[144:159], v[200:203], v[240:243], v[144:159]
    buffer_load_dwordx4 v[200:203], v7, s[12:15], s76 offen offset:2048 sc1
    v_exp_f32 v38, v38
    v_exp_f32 v39, v39
    v_exp_f32 v40, v40
    v_exp_f32 v41, v41
    v_exp_f32 v42, v42
    v_smfmac_f32_32x32x32_bf16 v[80:95], v[16:19], v[32:39], v64
    s_waitcnt lgkmcnt(1)
    ds_read_b128 v[16:19], v3 offset:14448
    v_mfma_f32_32x32x16_bf16 v[160:175], v[232:235], v[240:243], v[160:175]
    buffer_load_dwordx4 v[232:235], v7, s[12:15], s77 offen offset:2048 sc1
    v_exp_f32 v43, v43
    v_exp_f32 v44, v44
    v_exp_f32 v45, v45
    v_exp_f32 v46, v46
    v_exp_f32 v47, v47
L_T88_55:
L_P_T88:
    v_exp_f32 v48, v48
    v_exp_f32 v49, v49
    v_smfmac_f32_32x32x32_bf16 v[80:95], v[20:23], v[40:47], v64
    s_waitcnt lgkmcnt(1)
    ds_read_b128 v[20:23], v4 offset:14448
    v_exp_f32 v50, v50
    v_exp_f32 v51, v51
    v_exp_f32 v52, v52
    v_exp_f32 v53, v53
    v_mfma_f32_32x32x16_bf16 v[32:47], v[12:15], v[8:11], 0
    s_waitcnt lgkmcnt(1)
    ds_read_b128 v[12:15], v5 offset:18576
    s_waitcnt vmcnt(12)
    v_mfma_f32_32x32x16_bf16 v[144:159], v[204:207], v[244:247], v[144:159]
    buffer_load_dwordx4 v[204:207], v7, s[12:15], s76 offen offset:3072 sc1
    v_exp_f32 v54, v54
    v_exp_f32 v55, v55
    v_exp_f32 v56, v56
    v_exp_f32 v57, v57
    v_exp_f32 v58, v58
    v_smfmac_f32_32x32x32_bf16 v[80:95], v[16:19], v[48:55], v64
    s_waitcnt lgkmcnt(1)
    ds_read_b128 v[16:19], v3 offset:16512
    v_mfma_f32_32x32x16_bf16 v[160:175], v[236:239], v[244:247], v[160:175]
    buffer_load_dwordx4 v[236:239], v7, s[12:15], s77 offen offset:3072 sc1
    v_exp_f32 v59, v59
    v_exp_f32 v60, v60
    v_exp_f32 v61, v61
    v_exp_f32 v62, v62
    v_exp_f32 v63, v63
L_T89_56:
L_P_T89:
    s_setprio 0
    v_exp_f32 v32, v32
    v_exp_f32 v33, v33
    v_smfmac_f32_32x32x32_bf16 v[80:95], v[20:23], v[56:63], v64
    s_waitcnt lgkmcnt(1)
    ds_read_b128 v[20:23], v4 offset:16512
    v_exp_f32 v34, v34
    v_exp_f32 v35, v35
    v_exp_f32 v36, v36
    v_exp_f32 v37, v37
    v_mfma_f32_32x32x16_bf16 v[48:63], v[12:15], v[8:11], 0
    s_waitcnt lgkmcnt(1)
    ds_read_b128 v[12:15], v5 offset:20640
    v_exp_f32 v38, v38
    v_exp_f32 v39, v39
    v_exp_f32 v40, v40
    v_exp_f32 v41, v41
    v_exp_f32 v42, v42
    v_smfmac_f32_32x32x32_bf16 v[80:95], v[16:19], v[32:39], v64
    s_waitcnt lgkmcnt(1)
    ds_read_b128 v[16:19], v3 offset:18576
    v_exp_f32 v43, v43
    v_exp_f32 v44, v44
    v_exp_f32 v45, v45
    v_exp_f32 v46, v46
    v_exp_f32 v47, v47
L_T90_57:
L_P_T90:
    v_exp_f32 v48, v48
    v_exp_f32 v49, v49
    v_smfmac_f32_32x32x32_bf16 v[80:95], v[20:23], v[40:47], v64
    s_waitcnt lgkmcnt(1)
    ds_read_b128 v[20:23], v4 offset:18576
    v_exp_f32 v50, v50
    v_exp_f32 v51, v51
    v_exp_f32 v52, v52
    v_exp_f32 v53, v53
    v_mfma_f32_32x32x16_bf16 v[32:47], v[12:15], v[8:11], 0
    s_waitcnt lgkmcnt(1)
    ds_read_b128 v[12:15], v5 offset:22704
    v_exp_f32 v54, v54
    v_exp_f32 v55, v55
    v_exp_f32 v56, v56
    v_exp_f32 v57, v57
    v_exp_f32 v58, v58
    v_smfmac_f32_32x32x32_bf16 v[80:95], v[16:19], v[48:55], v64
    s_waitcnt lgkmcnt(1)
    ds_read_b128 v[16:19], v3 offset:20640
    v_exp_f32 v59, v59
    v_exp_f32 v60, v60
    v_exp_f32 v61, v61
    v_exp_f32 v62, v62
    v_exp_f32 v63, v63
L_T91_58:
L_P_T91:
    v_exp_f32 v32, v32
    v_exp_f32 v33, v33
    v_smfmac_f32_32x32x32_bf16 v[80:95], v[20:23], v[56:63], v64
    s_waitcnt lgkmcnt(1)
    ds_read_b128 v[20:23], v4 offset:20640
    v_add_u32 v28, s84, v2
    v_exp_f32 v34, v34
    v_exp_f32 v35, v35
    v_exp_f32 v36, v36
    v_exp_f32 v37, v37
    v_mfma_f32_32x32x16_bf16 v[48:63], v[12:15], v[8:11], 0
    s_waitcnt lgkmcnt(1)
    ds_read_b128 v[12:15], v5 offset:24768
    v_add_u32 v29, s85, v2
    v_exp_f32 v38, v38
    v_exp_f32 v39, v39
    v_exp_f32 v40, v40
    v_exp_f32 v41, v41
    v_exp_f32 v42, v42
    v_smfmac_f32_32x32x32_bf16 v[80:95], v[16:19], v[32:39], v64
    s_waitcnt lgkmcnt(1)
    ds_read_b128 v[16:19], v3 offset:22704
    v_add_u32 v30, s86, v2
    v_exp_f32 v43, v43
    v_exp_f32 v44, v44
    v_exp_f32 v45, v45
    v_exp_f32 v46, v46
    v_exp_f32 v47, v47
L_T92_59:
L_P_T92:
    v_exp_f32 v48, v48
    v_exp_f32 v49, v49
    v_smfmac_f32_32x32x32_bf16 v[80:95], v[20:23], v[40:47], v64
    s_waitcnt lgkmcnt(1)
    ds_read_b128 v[20:23], v4 offset:22704
    v_add_u32 v31, s87, v2
    v_exp_f32 v50, v50
    v_exp_f32 v51, v51
    v_exp_f32 v52, v52
    v_exp_f32 v53, v53
    v_mfma_f32_32x32x16_bf16 v[32:47], v[12:15], v[8:11], 0
    s_waitcnt lgkmcnt(1)
    ds_read_b128 v[12:15], v5 offset:26832
    v_and_b32 v6, 31, v1
    v_exp_f32 v54, v54
    v_exp_f32 v55, v55
    v_exp_f32 v56, v56
    v_exp_f32 v57, v57
    v_exp_f32 v58, v58
    v_smfmac_f32_32x32x32_bf16 v[80:95], v[16:19], v[48:55], v64
    s_waitcnt lgkmcnt(1)
    ds_read_b128 v[16:19], v3 offset:24768
    v_lshlrev_b32 v6, 11, v6
    v_exp_f32 v59, v59
    v_exp_f32 v60, v60
    v_exp_f32 v61, v61
    v_exp_f32 v62, v62
    v_exp_f32 v63, v63
L_T93_60:
L_P_T93:
    v_exp_f32 v32, v32
    v_exp_f32 v33, v33
    v_smfmac_f32_32x32x32_bf16 v[80:95], v[20:23], v[56:63], v64
    s_waitcnt lgkmcnt(1)
    ds_read_b128 v[20:23], v4 offset:24768
    v_lshrrev_b32 v138, 5, v1
    v_exp_f32 v34, v34
    v_exp_f32 v35, v35
    v_exp_f32 v36, v36
    v_exp_f32 v37, v37
    v_mfma_f32_32x32x16_bf16 v[48:63], v[12:15], v[8:11], 0
    s_waitcnt lgkmcnt(1)
    ds_read_b128 v[12:15], v5 offset:28896
    v_exp_f32 v38, v38
    v_exp_f32 v39, v39
    v_exp_f32 v40, v40
    v_exp_f32 v41, v41
    v_exp_f32 v42, v42
    v_smfmac_f32_32x32x32_bf16 v[80:95], v[16:19], v[32:39], v64
    s_waitcnt lgkmcnt(1)
    ds_read_b128 v[16:19], v3 offset:26832
    v_lshl_add_u32 v6, v138, 4, v6
    v_exp_f32 v43, v43
    v_exp_f32 v44, v44
    v_exp_f32 v45, v45
    v_exp_f32 v46, v46
    v_exp_f32 v47, v47
L_T94_61:
L_P_T94:
    v_exp_f32 v48, v48
    v_exp_f32 v49, v49
    v_smfmac_f32_32x32x32_bf16 v[80:95], v[20:23], v[40:47], v64
    s_waitcnt lgkmcnt(1)
    ds_read_b128 v[20:23], v4 offset:26832
    s_add_u32 s30, s72, 12582912
    v_exp_f32 v50, v50
    v_exp_f32 v51, v51
    v_exp_f32 v52, v52
    v_exp_f32 v53, v53
    v_mfma_f32_32x32x16_bf16 v[32:47], v[12:15], v[8:11], 0
    s_waitcnt lgkmcnt(1)
    ds_read_b128 v[12:15], v5 offset:30960
    s_add_u32 s31, s72, 12587008
    v_exp_f32 v54, v54
    v_exp_f32 v55, v55
    v_exp_f32 v56, v56
    v_exp_f32 v57, v57
    v_exp_f32 v58, v58
    v_smfmac_f32_32x32x32_bf16 v[80:95], v[16:19], v[48:55], v64
    s_waitcnt lgkmcnt(1)
    ds_read_b128 v[16:19], v3 offset:28896
    s_mov_b32 s40, 1736441856
    v_exp_f32 v59, v59
    v_exp_f32 v60, v60
    v_exp_f32 v61, v61
    v_exp_f32 v62, v62
    v_exp_f32 v63, v63
L_T95_62:
L_P_T95:
    v_exp_f32 v32, v32
    v_exp_f32 v33, v33
    v_smfmac_f32_32x32x32_bf16 v[80:95], v[20:23], v[56:63], v64
    s_waitcnt lgkmcnt(1)
    ds_read_b128 v[20:23], v4 offset:28896
    s_mov_b32 s33, 0xff
    v_exp_f32 v34, v34
    v_exp_f32 v35, v35
    v_exp_f32 v36, v36
    v_exp_f32 v37, v37
    v_mfma_f32_32x32x16_bf16 v[48:63], v[12:15], v[8:11], 0
    s_waitcnt lgkmcnt(1)
    s_mov_b32 s34, 0
    v_exp_f32 v38, v38
    v_exp_f32 v39, v39
    v_exp_f32 v40, v40
    v_exp_f32 v41, v41
    v_exp_f32 v42, v42
    v_smfmac_f32_32x32x32_bf16 v[80:95], v[16:19], v[32:39], v64
    s_waitcnt lgkmcnt(0)
    ds_read_b128 v[16:19], v3 offset:30960
    v_exp_f32 v43, v43
    v_exp_f32 v44, v44
    v_exp_f32 v45, v45
    v_exp_f32 v46, v46
    v_exp_f32 v47, v47
L_T96_63:
L_P_T96:
    v_exp_f32 v48, v48
    v_exp_f32 v49, v49
    v_smfmac_f32_32x32x32_bf16 v[80:95], v[20:23], v[40:47], v64
    ds_read_b128 v[20:23], v4 offset:30960
    v_exp_f32 v50, v50
    v_exp_f32 v51, v51
    v_exp_f32 v52, v52
    v_exp_f32 v53, v53
    s_waitcnt lgkmcnt(1)
    v_exp_f32 v54, v54
    v_exp_f32 v55, v55
    v_exp_f32 v56, v56
    v_exp_f32 v57, v57
    v_exp_f32 v58, v58
    v_smfmac_f32_32x32x32_bf16 v[80:95], v[16:19], v[48:55], v64
    v_exp_f32 v59, v59
    v_exp_f32 v60, v60
    v_exp_f32 v61, v61
    v_exp_f32 v62, v62
    v_exp_f32 v63, v63
    s_waitcnt vmcnt(24)
L_loopend:
L_P_loopend:
    s_waitcnt lgkmcnt(0)
    s_nop 1
    v_smfmac_f32_32x32x32_bf16 v[80:95], v[20:23], v[56:63], v64
    s_setprio 3
    s_nop 7
    s_nop 4
    v_rcp_f32 v27, v88
    v_fma_f32 v26, v80, 0, v88
    v_fma_f32 v26, v81, 0, v26
    v_fma_f32 v26, v82, 0, v26
    v_fma_f32 v26, v83, 0, v26
    v_fma_f32 v26, v84, 0, v26
    v_fma_f32 v26, v85, 0, v26
    v_fma_f32 v26, v86, 0, v26
    v_fma_f32 v26, v87, 0, v26
    v_add_f32 v26, v26, v27
    v_cmp_nlt_f32 vcc, v26, s40
    s_cmp_eq_u32 s38, 0
    s_cbranch_scc0 L_fin
    s_nop 1
    s_cbranch_vccnz L_fallback
L_fin:
    v_mul_f32 v27, v27, v137
    v_mul_f32 v80, v80, v27
    v_mul_f32 v81, v81, v27
    v_mul_f32 v82, v82, v27
    v_mul_f32 v83, v83, v27
    v_mul_f32 v84, v84, v27
    v_mul_f32 v85, v85, v27
    v_mul_f32 v86, v86, v27
    v_mul_f32 v87, v87, v27
    v_cvt_pk_bf16_f32 v80, v80, v81
    v_cvt_pk_bf16_f32 v81, v82, v83
    v_cvt_pk_bf16_f32 v82, v84, v85
    v_cvt_pk_bf16_f32 v83, v86, v87
    v_min_u32 v80, -2, v80
    v_min_u32 v81, -2, v81
    v_min_u32 v82, -2, v82
    v_min_u32 v83, -2, v83
    buffer_store_dwordx4 v[80:83], v2, s[12:15], s57 offen sc1
    s_cmp_ge_u32 s20, 4
    s_cbranch_scc0 L_t0
    s_barrier
L_t0:
    s_waitcnt vmcnt(0)
    buffer_load_dwordx4 v[112:115], v2, s[12:15], s30 offen offset:0 sc1
    buffer_load_dwordx4 v[116:119], v2, s[12:15], s30 offen offset:1024 sc1
    buffer_load_dwordx4 v[120:123], v2, s[12:15], s30 offen offset:2048 sc1
    buffer_load_dwordx4 v[124:127], v2, s[12:15], s30 offen offset:3072 sc1
    buffer_load_dwordx4 v[128:131], v2, s[12:15], s31 offen offset:0 sc1
    buffer_load_dwordx4 v[132:135], v2, s[12:15], s31 offen offset:1024 sc1
    buffer_load_dwordx4 v[240:243], v2, s[12:15], s31 offen offset:2048 sc1
    buffer_load_dwordx4 v[244:247], v2, s[12:15], s31 offen offset:3072 sc1
    s_waitcnt vmcnt(7)
    v_max3_u32 v24, v112, v113, v114
    v_max_u32 v24, v24, v115
    v_cmp_eq_u32 vcc, -1, v24
    s_nop 0
    s_cbranch_vccnz L_ck0
    v_mfma_f32_32x32x16_bf16 v[144:159], v[176:179], v[112:115], v[144:159]
    v_mfma_f32_32x32x16_bf16 v[160:175], v[208:211], v[112:115], v[160:175]
    s_bitset0_b32 s33, 0
L_ck0:
    s_waitcnt vmcnt(6)
    v_max3_u32 v24, v116, v117, v118
    v_max_u32 v24, v24, v119
    v_cmp_eq_u32 vcc, -1, v24
    s_nop 0
    s_cbranch_vccnz L_ck1
    v_mfma_f32_32x32x16_bf16 v[144:159], v[180:183], v[116:119], v[144:159]
    v_mfma_f32_32x32x16_bf16 v[160:175], v[212:215], v[116:119], v[160:175]
    s_bitset0_b32 s33, 1
L_ck1:
    s_waitcnt vmcnt(5)
    v_max3_u32 v24, v120, v121, v122
    v_max_u32 v24, v24, v123
    v_cmp_eq_u32 vcc, -1, v24
    s_nop 0
    s_cbranch_vccnz L_ck2
    v_mfma_f32_32x32x16_bf16 v[144:159], v[184:187], v[120:123], v[144:159]
    v_mfma_f32_32x32x16_bf16 v[160:175], v[216:219], v[120:123], v[160:175]
    s_bitset0_b32 s33, 2
L_ck2:
    s_waitcnt vmcnt(4)
    v_max3_u32 v24, v124, v125, v126
    v_max_u32 v24, v24, v127
    v_cmp_eq_u32 vcc, -1, v24
    s_nop 0
    s_cbranch_vccnz L_ck3
    v_mfma_f32_32x32x16_bf16 v[144:159], v[188:191], v[124:127], v[144:159]
    v_mfma_f32_32x32x16_bf16 v[160:175], v[220:223], v[124:127], v[160:175]
    s_bitset0_b32 s33, 3
L_ck3:
    s_waitcnt vmcnt(3)
    v_max3_u32 v24, v128, v129, v130
    v_max_u32 v24, v24, v131
    v_cmp_eq_u32 vcc, -1, v24
    s_nop 0
    s_cbranch_vccnz L_ck4
    v_mfma_f32_32x32x16_bf16 v[144:159], v[192:195], v[128:131], v[144:159]
    v_mfma_f32_32x32x16_bf16 v[160:175], v[224:227], v[128:131], v[160:175]
    s_bitset0_b32 s33, 4
L_ck4:
    s_waitcnt vmcnt(2)
    v_max3_u32 v24, v132, v133, v134
    v_max_u32 v24, v24, v135
    v_cmp_eq_u32 vcc, -1, v24
    s_nop 0
    s_cbranch_vccnz L_ck5
    v_mfma_f32_32x32x16_bf16 v[144:159], v[196:199], v[132:135], v[144:159]
    v_mfma_f32_32x32x16_bf16 v[160:175], v[228:231], v[132:135], v[160:175]
    s_bitset0_b32 s33, 5
L_ck5:
    s_waitcnt vmcnt(1)
    v_max3_u32 v24, v240, v241, v242
    v_max_u32 v24, v24, v243
    v_cmp_eq_u32 vcc, -1, v24
    s_nop 0
    s_cbranch_vccnz L_ck6
    v_mfma_f32_32x32x16_bf16 v[144:159], v[200:203], v[240:243], v[144:159]
    v_mfma_f32_32x32x16_bf16 v[160:175], v[232:235], v[240:243], v[160:175]
    s_bitset0_b32 s33, 6
L_ck6:
    s_waitcnt vmcnt(0)
    v_max3_u32 v24, v244, v245, v246
    v_max_u32 v24, v24, v247
    v_cmp_eq_u32 vcc, -1, v24
    s_nop 0
    s_cbranch_vccnz L_ck7
    v_mfma_f32_32x32x16_bf16 v[144:159], v[204:207], v[244:247], v[144:159]
    v_mfma_f32_32x32x16_bf16 v[160:175], v[236:239], v[244:247], v[160:175]
    s_bitset0_b32 s33, 7
L_ck7:
L_tchk:
    s_cmp_eq_u32 s33, 0
    s_cbranch_scc0 L_tre
L_tgo:
L_P_tgo:
    s_nop 7
    s_nop 3
    ds_write_b128 v28, v[152:155] offset:0
    ds_write_b128 v28, v[156:159] offset:1024
    ds_write_b128 v29, v[160:163] offset:0
    ds_write_b128 v29, v[164:167] offset:1024
    ds_write_b128 v30, v[168:171] offset:0
    ds_write_b128 v30, v[172:175] offset:1024
    s_waitcnt lgkmcnt(0)
    s_barrier
    ds_read_b128 v[32:35], v31 offset:0
    ds_read_b128 v[36:39], v31 offset:1024
    ds_read_b128 v[40:43], v31 offset:2048
    ds_read_b128 v[44:47], v31 offset:3072
    ds_read_b128 v[48:51], v31 offset:4096
    ds_read_b128 v[52:55], v31 offset:5120
    s_waitcnt lgkmcnt(4)
    v_add_f32 v144, v144, v32
    v_add_f32 v145, v145, v33
    v_add_f32 v146, v146, v34
    v_add_f32 v147, v147, v35
    v_add_f32 v148, v148, v36
    v_add_f32 v149, v149, v37
    v_add_f32 v150, v150, v38
    v_add_f32 v151, v151, v39
    s_waitcnt lgkmcnt(2)
    v_add_f32 v144, v144, v40
    v_add_f32 v145, v145, v41
    v_add_f32 v146, v146, v42
    v_add_f32 v147, v147, v43
    v_add_f32 v148, v148, v44
    v_add_f32 v149, v149, v45
    v_add_f32 v150, v150, v46
    v_add_f32 v151, v151, v47
    s_waitcnt lgkmcnt(0)
    v_add_f32 v144, v144, v48
    v_add_f32 v145, v145, v49
    v_add_f32 v146, v146, v50
    v_add_f32 v147, v147, v51
    v_add_f32 v148, v148, v52
    v_add_f32 v149, v149, v53
    v_add_f32 v150, v150, v54
    v_add_f32 v151, v151, v55
    v_cvt_pk_bf16_f32 v32, v144, v145
    v_cvt_pk_bf16_f32 v33, v146, v147
    v_cvt_pk_bf16_f32 v34, v148, v149
    v_cvt_pk_bf16_f32 v35, v150, v151
    s_nop 1
    v_permlane32_swap_b32 v32, v34
    v_permlane32_swap_b32 v33, v35
    s_nop 1
    buffer_store_dwordx4 v[32:35], v6, s[80:83], s73 offen
    s_cmp_ge_u32 s20, 4
    s_cbranch_scc1 L_t1
    s_barrier
L_t1:
L_end:
    s_endpgm
L_P_end:
L_tre:
    s_add_u32 s34, s34, 1
    s_cmp_gt_u32 s34, 40000
    s_cbranch_scc1 L_tgo
    s_sleep 1
    s_bitcmp1_b32 s33, 0
    s_cbranch_scc0 L_rl0
    buffer_load_dwordx4 v[112:115], v2, s[12:15], s30 offen offset:0 sc1
L_rl0:
    s_bitcmp1_b32 s33, 1
    s_cbranch_scc0 L_rl1
    buffer_load_dwordx4 v[116:119], v2, s[12:15], s30 offen offset:1024 sc1
L_rl1:
    s_bitcmp1_b32 s33, 2
    s_cbranch_scc0 L_rl2
    buffer_load_dwordx4 v[120:123], v2, s[12:15], s30 offen offset:2048 sc1
L_rl2:
    s_bitcmp1_b32 s33, 3
    s_cbranch_scc0 L_rl3
    buffer_load_dwordx4 v[124:127], v2, s[12:15], s30 offen offset:3072 sc1
L_rl3:
    s_bitcmp1_b32 s33, 4
    s_cbranch_scc0 L_rl4
    buffer_load_dwordx4 v[128:131], v2, s[12:15], s31 offen offset:0 sc1
L_rl4:
    s_bitcmp1_b32 s33, 5
    s_cbranch_scc0 L_rl5
    buffer_load_dwordx4 v[132:135], v2, s[12:15], s31 offen offset:1024 sc1
L_rl5:
    s_bitcmp1_b32 s33, 6
    s_cbranch_scc0 L_rl6
    buffer_load_dwordx4 v[240:243], v2, s[12:15], s31 offen offset:2048 sc1
L_rl6:
    s_bitcmp1_b32 s33, 7
    s_cbranch_scc0 L_rl7
    buffer_load_dwordx4 v[244:247], v2, s[12:15], s31 offen offset:3072 sc1
L_rl7:
    s_waitcnt vmcnt(0)
    s_bitcmp1_b32 s33, 0
    s_cbranch_scc0 L_rk0
    v_max3_u32 v24, v112, v113, v114
    v_max_u32 v24, v24, v115
    v_cmp_eq_u32 vcc, -1, v24
    s_nop 0
    s_cbranch_vccnz L_rk0
    v_mfma_f32_32x32x16_bf16 v[144:159], v[176:179], v[112:115], v[144:159]
    v_mfma_f32_32x32x16_bf16 v[160:175], v[208:211], v[112:115], v[160:175]
    s_bitset0_b32 s33, 0
L_rk0:
    s_bitcmp1_b32 s33, 1
    s_cbranch_scc0 L_rk1
    v_max3_u32 v24, v116, v117, v118
    v_max_u32 v24, v24, v119
    v_cmp_eq_u32 vcc, -1, v24
    s_nop 0
    s_cbranch_vccnz L_rk1
    v_mfma_f32_32x32x16_bf16 v[144:159], v[180:183], v[116:119], v[144:159]
    v_mfma_f32_32x32x16_bf16 v[160:175], v[212:215], v[116:119], v[160:175]
    s_bitset0_b32 s33, 1
L_rk1:
    s_bitcmp1_b32 s33, 2
    s_cbranch_scc0 L_rk2
    v_max3_u32 v24, v120, v121, v122
    v_max_u32 v24, v24, v123
    v_cmp_eq_u32 vcc, -1, v24
    s_nop 0
    s_cbranch_vccnz L_rk2
    v_mfma_f32_32x32x16_bf16 v[144:159], v[184:187], v[120:123], v[144:159]
    v_mfma_f32_32x32x16_bf16 v[160:175], v[216:219], v[120:123], v[160:175]
    s_bitset0_b32 s33, 2
L_rk2:
    s_bitcmp1_b32 s33, 3
    s_cbranch_scc0 L_rk3
    v_max3_u32 v24, v124, v125, v126
    v_max_u32 v24, v24, v127
    v_cmp_eq_u32 vcc, -1, v24
    s_nop 0
    s_cbranch_vccnz L_rk3
    v_mfma_f32_32x32x16_bf16 v[144:159], v[188:191], v[124:127], v[144:159]
    v_mfma_f32_32x32x16_bf16 v[160:175], v[220:223], v[124:127], v[160:175]
    s_bitset0_b32 s33, 3
L_rk3:
    s_bitcmp1_b32 s33, 4
    s_cbranch_scc0 L_rk4
    v_max3_u32 v24, v128, v129, v130
    v_max_u32 v24, v24, v131
    v_cmp_eq_u32 vcc, -1, v24
    s_nop 0
    s_cbranch_vccnz L_rk4
    v_mfma_f32_32x32x16_bf16 v[144:159], v[192:195], v[128:131], v[144:159]
    v_mfma_f32_32x32x16_bf16 v[160:175], v[224:227], v[128:131], v[160:175]
    s_bitset0_b32 s33, 4
L_rk4:
    s_bitcmp1_b32 s33, 5
    s_cbranch_scc0 L_rk5
    v_max3_u32 v24, v132, v133, v134
    v_max_u32 v24, v24, v135
    v_cmp_eq_u32 vcc, -1, v24
    s_nop 0
    s_cbranch_vccnz L_rk5
    v_mfma_f32_32x32x16_bf16 v[144:159], v[196:199], v[132:135], v[144:159]
    v_mfma_f32_32x32x16_bf16 v[160:175], v[228:231], v[132:135], v[160:175]
    s_bitset0_b32 s33, 5
L_rk5:
    s_bitcmp1_b32 s33, 6
    s_cbranch_scc0 L_rk6
    v_max3_u32 v24, v240, v241, v242
    v_max_u32 v24, v24, v243
    v_cmp_eq_u32 vcc, -1, v24
    s_nop 0
    s_cbranch_vccnz L_rk6
    v_mfma_f32_32x32x16_bf16 v[144:159], v[200:203], v[240:243], v[144:159]
    v_mfma_f32_32x32x16_bf16 v[160:175], v[232:235], v[240:243], v[160:175]
    s_bitset0_b32 s33, 6
L_rk6:
    s_bitcmp1_b32 s33, 7
    s_cbranch_scc0 L_rk7
    v_max3_u32 v24, v244, v245, v246
    v_max_u32 v24, v24, v247
    v_cmp_eq_u32 vcc, -1, v24
    s_nop 0
    s_cbranch_vccnz L_rk7
    v_mfma_f32_32x32x16_bf16 v[144:159], v[204:207], v[244:247], v[144:159]
    v_mfma_f32_32x32x16_bf16 v[160:175], v[236:239], v[244:247], v[160:175]
    s_bitset0_b32 s33, 7
L_rk7:
    s_branch L_tchk
L_slow1:
    s_and_b32 s34, s43, s42
    s_cbranch_scc0 L_slp1
    s_mov_b32 m0, s41
    s_ff1_i32_b32 s28, s34
    s_bitset0_b32 s42, s28
    s_lshl_b32 s28, s28, 13
    s_add_u32 s33, s28, s40
    buffer_load_dwordx4 v2, s[12:15], s33 offen sc1 lds
    buffer_load_dwordx4 v2, s[12:15], s33 offen offset:1024 sc1 lds
    s_add_u32 m0, s41, 16
    s_add_u32 s41, s41, 16512
    buffer_load_dwordx4 v2, s[12:15], s33 offen offset:2048 sc1 lds
    buffer_load_dwordx4 v2, s[12:15], s33 offen offset:3072 sc1 lds
    s_add_u32 s44, s44, 1
    s_cmp_ge_u32 s44, 4
    s_cbranch_scc1 L_slow1_ret
    s_branch L_slow1
L_slp1:
    s_add_u32 s47, s47, 1
    s_cmp_gt_u32 s47, 160000
    s_cselect_b32 s43, 0x5555, s43
    s_sleep 2
    s_mov_b32 exec_lo, 0xffff
    s_mov_b32 exec_hi, 0
    buffer_load_dword v30, v31, s[12:15], s45 offen sc1
    s_mov_b64 exec, -1
    s_waitcnt vmcnt(0)
    v_add_u32 v29, -1, v30
    v_cmp_gt_u32 vcc, 3, v29
    s_nop 0
    s_lshr_b32 s28, vcc_lo, 1
    s_and_b32 s28, s28, vcc_lo
    s_and_b32 s28, s28, 0x5555
    s_or_b32 s43, s43, s28
    s_branch L_slow1
L_slow2:
    s_and_b32 s34, s43, s42
    s_cbranch_scc0 L_slp2
    s_mov_b32 m0, s41
    s_ff1_i32_b32 s28, s34
    s_bitset0_b32 s42, s28
    s_lshl_b32 s28, s28, 13
    s_add_u32 s33, s28, s40
    buffer_load_dwordx4 v2, s[12:15], s33 offen sc1 lds
    buffer_load_dwordx4 v2, s[12:15], s33 offen offset:1024 sc1 lds
    s_add_u32 m0, s41, 16
    s_add_u32 s41, s41, 16512
    buffer_load_dwordx4 v2, s[12:15], s33 offen offset:2048 sc1 lds
    buffer_load_dwordx4 v2, s[12:15], s33 offen offset:3072 sc1 lds
    s_add_u32 s44, s44, 1
    s_cmp_ge_u32 s44, 8
    s_cbranch_scc1 L_slow2_ret
    s_branch L_slow2
L_slp2:
    s_add_u32 s47, s47, 1
    s_cmp_gt_u32 s47, 160000
    s_cselect_b32 s43, 0x5555, s43
    s_sleep 2
    s_mov_b32 exec_lo, 0xffff
    s_mov_b32 exec_hi, 0
    buffer_load_dword v30, v31, s[12:15], s45 offen sc1
    s_mov_b64 exec, -1
    s_waitcnt vmcnt(0)
    v_add_u32 v29, -1, v30
    v_cmp_gt_u32 vcc, 3, v29
    s_nop 0
    s_lshr_b32 s28, vcc_lo, 1
    s_and_b32 s28, s28, vcc_lo
    s_and_b32 s28, s28, 0x5555
    s_or_b32 s43, s43, s28
    s_branch L_slow2
L_A_poll:
    s_mov_b32 s31, 0
L_A_poll1:
    s_add_u32 s31, s31, 1
    s_sleep 2
    buffer_load_dword v24, v139, s[12:15], s46 offen sc1
    s_waitcnt vmcnt(0)
    v_readfirstlane_b32 s28, v24
    s_cmp_gt_u32 s31, 40000
    s_cbranch_scc1 L_A_go
    s_cmp_ge_u32 s28, 2
    s_cbranch_scc1 L_A_go
    s_branch L_A_poll1
L_A_nohalo:
    v_mov_b32 v96, v120
    v_mov_b32 v97, v121
    v_mov_b32 v98, v122
    v_mov_b32 v99, v123
    v_mov_b32 v100, v124
    v_mov_b32 v101, v125
    v_mov_b32 v102, v126
    v_mov_b32 v103, v127
    v_mov_b32 v106, v134
    v_mov_b32 v107, v135
    s_branch L_A_hret
L_atx0:
    v_mfma_f32_32x32x16_bf16 v[192:207], v[120:123], v[112:115], v[160:175]
    v_mfma_f32_32x32x16_bf16 v[208:223], v[96:99], v[112:115], v[176:191]
    s_nop 7
    s_nop 2
    v_max3_f32 v26, v192, v193, v194
    v_max3_f32 v27, v195, v196, v197
    v_max3_f32 v26, v26, v198, v199
    v_max3_f32 v27, v27, v200, v201
    v_max3_f32 v26, v26, v202, v203
    v_max3_f32 v27, v27, v204, v205
    v_max3_f32 v26, v26, v206, v207
    v_max3_f32 v27, v27, v220, v221
    v_max3_f32 v26, v26, v222, v223
    v_max_f32 v26, v26, v27
    v_mov_b32 v27, v26
    s_nop 1
    v_permlane32_swap_b32 v26, v27
    s_nop 1
    v_max_f32 v26, v26, v27
    v_sub_f32 v192, v192, v26
    v_sub_f32 v193, v193, v26
    v_sub_f32 v194, v194, v26
    v_sub_f32 v195, v195, v26
    v_sub_f32 v196, v196, v26
    v_sub_f32 v197, v197, v26
    v_sub_f32 v198, v198, v26
    v_sub_f32 v199, v199, v26
    v_sub_f32 v200, v200, v26
    v_sub_f32 v201, v201, v26
    v_sub_f32 v202, v202, v26
    v_sub_f32 v203, v203, v26
    v_sub_f32 v204, v204, v26
    v_sub_f32 v205, v205, v26
    v_sub_f32 v206, v206, v26
    v_sub_f32 v207, v207, v26
    v_sub_f32 v220, v220, v26
    v_sub_f32 v221, v221, v26
    v_sub_f32 v222, v222, v26
    v_sub_f32 v223, v223, v26
    v_exp_f32 v192, v192
    v_exp_f32 v193, v193
    v_exp_f32 v194, v194
    v_exp_f32 v195, v195
    v_exp_f32 v196, v196
    v_exp_f32 v197, v197
    v_exp_f32 v198, v198
    v_exp_f32 v199, v199
    v_exp_f32 v200, v200
    v_exp_f32 v201, v201
    v_exp_f32 v202, v202
    v_exp_f32 v203, v203
    v_exp_f32 v204, v204
    v_exp_f32 v205, v205
    v_exp_f32 v206, v206
    v_exp_f32 v207, v207
    v_exp_f32 v220, v220
    v_exp_f32 v221, v221
    v_exp_f32 v222, v222
    v_exp_f32 v223, v223
    v_cvt_pk_bf16_f32 v158, v220, v221
    v_cvt_pk_bf16_f32 v192, v192, v193
    v_cvt_pk_bf16_f32 v193, v194, v195
    v_cvt_pk_bf16_f32 v194, v196, v197
    v_cvt_pk_bf16_f32 v195, v198, v199
    v_cvt_pk_bf16_f32 v196, v200, v201
    v_cvt_pk_bf16_f32 v197, v202, v203
    v_cvt_pk_bf16_f32 v198, v204, v205
    v_cvt_pk_bf16_f32 v199, v206, v207
    v_cvt_pk_bf16_f32 v159, v222, v223
    s_nop 0
    v_mfma_f32_32x32x16_bf16 v[240:255], v[152:155], v[192:195], 0
    v_mfma_f32_32x32x16_bf16 v[224:239], v[128:131], v[192:195], 0
    v_mfma_f32_32x32x16_bf16 v[240:255], v[152:155], v[196:199], v[240:255]
    v_mfma_f32_32x32x16_bf16 v[224:239], v[132:135], v[196:199], v[224:239]
    v_mfma_f32_32x32x16_bf16 v[240:255], v[152:155], v[156:159], v[240:255]
    v_mfma_f32_32x32x16_bf16 v[224:239], v[104:107], v[156:159], v[224:239]
    s_nop 7
    s_nop 2
    v_rcp_f32 v26, v240
    s_nop 0
    s_branch L_atr0
L_atx1:
    v_mfma_f32_32x32x16_bf16 v[192:207], v[124:127], v[116:119], v[160:175]
    v_mfma_f32_32x32x16_bf16 v[208:223], v[100:103], v[116:119], v[176:191]
    s_nop 7
    s_nop 2
    v_max3_f32 v26, v192, v193, v194
    v_max3_f32 v27, v195, v196, v197
    v_max3_f32 v26, v26, v198, v199
    v_max3_f32 v27, v27, v200, v201
    v_max3_f32 v26, v26, v202, v203
    v_max3_f32 v27, v27, v204, v205
    v_max3_f32 v26, v26, v206, v207
    v_max3_f32 v27, v27, v220, v221
    v_max3_f32 v26, v26, v222, v223
    v_max_f32 v26, v26, v27
    v_mov_b32 v27, v26
    s_nop 1
    v_permlane32_swap_b32 v26, v27
    s_nop 1
    v_max_f32 v26, v26, v27
    v_sub_f32 v192, v192, v26
    v_sub_f32 v193, v193, v26
    v_sub_f32 v194, v194, v26
    v_sub_f32 v195, v195, v26
    v_sub_f32 v196, v196, v26
    v_sub_f32 v197, v197, v26
    v_sub_f32 v198, v198, v26
    v_sub_f32 v199, v199, v26
    v_sub_f32 v200, v200, v26
    v_sub_f32 v201, v201, v26
    v_sub_f32 v202, v202, v26
    v_sub_f32 v203, v203, v26
    v_sub_f32 v204, v204, v26
    v_sub_f32 v205, v205, v26
    v_sub_f32 v206, v206, v26
    v_sub_f32 v207, v207, v26
    v_sub_f32 v220, v220, v26
    v_sub_f32 v221, v221, v26
    v_sub_f32 v222, v222, v26
    v_sub_f32 v223, v223, v26
    v_exp_f32 v192, v192
    v_exp_f32 v193, v193
    v_exp_f32 v194, v194
    v_exp_f32 v195, v195
    v_exp_f32 v196, v196
    v_exp_f32 v197, v197
    v_exp_f32 v198, v198
    v_exp_f32 v199, v199
    v_exp_f32 v200, v200
    v_exp_f32 v201, v201
    v_exp_f32 v202, v202
    v_exp_f32 v203, v203
    v_exp_f32 v204, v204
    v_exp_f32 v205, v205
    v_exp_f32 v206, v206
    v_exp_f32 v207, v207
    v_exp_f32 v220, v220
    v_exp_f32 v221, v221
    v_exp_f32 v222, v222
    v_exp_f32 v223, v223
    v_cvt_pk_bf16_f32 v158, v220, v221
    v_cvt_pk_bf16_f32 v192, v192, v193
    v_cvt_pk_bf16_f32 v193, v194, v195
    v_cvt_pk_bf16_f32 v194, v196, v197
    v_cvt_pk_bf16_f32 v195, v198, v199
    v_cvt_pk_bf16_f32 v196, v200, v201
    v_cvt_pk_bf16_f32 v197, v202, v203
    v_cvt_pk_bf16_f32 v198, v204, v205
    v_cvt_pk_bf16_f32 v199, v206, v207
    v_cvt_pk_bf16_f32 v159, v222, v223
    s_nop 0
    v_mfma_f32_32x32x16_bf16 v[240:255], v[152:155], v[192:195], 0
    v_mfma_f32_32x32x16_bf16 v[224:239], v[128:131], v[192:195], 0
    v_mfma_f32_32x32x16_bf16 v[240:255], v[152:155], v[196:199], v[240:255]
    v_mfma_f32_32x32x16_bf16 v[224:239], v[132:135], v[196:199], v[224:239]
    v_mfma_f32_32x32x16_bf16 v[240:255], v[152:155], v[156:159], v[240:255]
    v_mfma_f32_32x32x16_bf16 v[224:239], v[104:107], v[156:159], v[224:239]
    s_nop 7
    s_nop 2
    v_rcp_f32 v26, v240
    s_nop 0
    s_branch L_atr1
L_c1:
    s_mov_b32 s79, 0
L_c1l:
    s_add_u32 s79, s79, 1
    s_sleep 2
    buffer_load_dword v142, v141, s[12:15], 0 offen sc1
    s_waitcnt vmcnt(0)
    v_cmp_gt_u32 vcc, 2, v142
    s_cmp_gt_u32 s79, 40000
    s_cbranch_scc1 L_c1_ret
    s_and_b32 s75, vcc_hi, 0xff00ff00
    s_or_b32 s75, s75, vcc_lo
    s_cbranch_scc1 L_c1l
    s_branch L_c1_ret
L_c2:
    s_mov_b32 s79, 0
L_c2l:
    s_add_u32 s79, s79, 1
    s_sleep 2
    buffer_load_dword v143, v141, s[12:15], 0 offen sc1
    s_waitcnt vmcnt(0)
    v_cmp_ne_u32 vcc, 3, v143
    s_cmp_gt_u32 s79, 40000
    s_cbranch_scc1 L_c2_ret
    s_and_b32 s75, vcc_hi, 0x00ff00ff
    s_cbranch_scc1 L_c2l
    s_branch L_c2_ret
L_P_fb:
L_fallback:
    s_mov_b32 s38, 1
    v_subrev_u32 v5, 99072, v5
    v_subrev_u32 v3, 99072, v3
    v_subrev_u32 v4, 99072, v4
    v_mov_b32 v26, 4284592614
    s_mov_b32 s39, 0
L_fb_loop:
    ds_read_b128 v[12:15], v5
    v_add_u32 v5, 2064, v5
    s_waitcnt lgkmcnt(0)
    v_mfma_f32_32x32x16_bf16 v[32:47], v[12:15], v[8:11], 0
    s_nop 7
    s_nop 3
    v_max3_f32 v26, v26, v32, v33
    v_max3_f32 v26, v26, v34, v35
    v_max3_f32 v26, v26, v36, v37
    v_max3_f32 v26, v26, v38, v39
    v_max3_f32 v26, v26, v40, v41
    v_max3_f32 v26, v26, v42, v43
    v_max3_f32 v26, v26, v44, v45
    v_max3_f32 v26, v26, v46, v47
    s_add_u32 s39, s39, 1
    s_cmp_lt_u32 s39, 64
    s_cbranch_scc1 L_fb_loop
    v_subrev_u32 v5, 132096, v5
    v_mov_b32 v27, v26
    s_nop 1
    v_permlane32_swap_b32 v26, v27
    s_nop 1
    v_max_f32 v26, v26, v27
    v_sub_f32 v112, 0, v26
    v_sub_f32 v113, 0, v26
    v_sub_f32 v114, 0, v26
    v_sub_f32 v115, 0, v26
    v_sub_f32 v116, 0, v26
    v_sub_f32 v117, 0, v26
    v_sub_f32 v118, 0, v26
    v_sub_f32 v119, 0, v26
    v_sub_f32 v120, 0, v26
    v_sub_f32 v121, 0, v26
    v_sub_f32 v122, 0, v26
    v_sub_f32 v123, 0, v26
    v_sub_f32 v124, 0, v26
    v_sub_f32 v125, 0, v26
    v_sub_f32 v126, 0, v26
    v_sub_f32 v127, 0, v26
    v_mov_b32 v56, 0
    v_mov_b32 v16, 0
    v_mov_b32 v57, 0
    v_mov_b32 v17, 0
    v_mov_b32 v58, 0
    v_mov_b32 v18, 0
    v_mov_b32 v59, 0
    v_mov_b32 v19, 0
    v_mov_b32 v60, 0
    v_mov_b32 v20, 0
    v_mov_b32 v61, 0
    v_mov_b32 v21, 0
    v_mov_b32 v62, 0
    v_mov_b32 v22, 0
    v_mov_b32 v63, 0
    v_mov_b32 v23, 0
    v_mov_b32 v80, 0
    v_mov_b32 v81, 0
    v_mov_b32 v82, 0
    v_mov_b32 v83, 0
    v_mov_b32 v84, 0
    v_mov_b32 v85, 0
    v_mov_b32 v86, 0
    v_mov_b32 v87, 0
    v_mov_b32 v88, 0
    v_mov_b32 v89, 0
    v_mov_b32 v90, 0
    v_mov_b32 v91, 0
    v_mov_b32 v92, 0
    v_mov_b32 v93, 0
    v_mov_b32 v94, 0
    v_mov_b32 v95, 0
    ds_read_b128 v[24:27], v5
    ds_read_b128 v[12:15], v5 offset:2064
    ds_read_b128 v[16:19], v3
    s_waitcnt lgkmcnt(0)
    v_mfma_f32_32x32x16_bf16 v[32:47], v[24:27], v[8:11], v[112:127]
    s_mov_b32 s39, 0
    s_nop 7
    s_nop 3
L_fb2:
    v_exp_f32 v32, v32
    v_exp_f32 v33, v33
    v_smfmac_f32_32x32x32_bf16 v[80:95], v[20:23], v[56:63], v64
    s_waitcnt lgkmcnt(1)
    ds_read_b128 v[20:23], v4 offset:0
    v_exp_f32 v34, v34
    v_exp_f32 v35, v35
    v_exp_f32 v36, v36
    v_exp_f32 v37, v37
    v_mfma_f32_32x32x16_bf16 v[48:63], v[12:15], v[8:11], v[112:127]
    s_waitcnt lgkmcnt(1)
    ds_read_b128 v[12:15], v5 offset:4128
    v_exp_f32 v38, v38
    v_exp_f32 v39, v39
    v_exp_f32 v40, v40
    v_exp_f32 v41, v41
    v_exp_f32 v42, v42
    v_smfmac_f32_32x32x32_bf16 v[80:95], v[16:19], v[32:39], v64
    s_waitcnt lgkmcnt(1)
    ds_read_b128 v[16:19], v3 offset:2064
    v_exp_f32 v43, v43
    v_exp_f32 v44, v44
    v_exp_f32 v45, v45
    v_exp_f32 v46, v46
    v_exp_f32 v47, v47
    v_exp_f32 v48, v48
    v_exp_f32 v49, v49
    v_smfmac_f32_32x32x32_bf16 v[80:95], v[20:23], v[40:47], v64
    s_waitcnt lgkmcnt(1)
    ds_read_b128 v[20:23], v4 offset:2064
    v_exp_f32 v50, v50
    v_exp_f32 v51, v51
    v_exp_f32 v52, v52
    v_exp_f32 v53, v53
    v_mfma_f32_32x32x16_bf16 v[32:47], v[12:15], v[8:11], v[112:127]
    s_waitcnt lgkmcnt(1)
    ds_read_b128 v[12:15], v5 offset:6192
    v_exp_f32 v54, v54
    v_exp_f32 v55, v55
    v_exp_f32 v56, v56
    v_exp_f32 v57, v57
    v_exp_f32 v58, v58
    v_smfmac_f32_32x32x32_bf16 v[80:95], v[16:19], v[48:55], v64
    s_waitcnt lgkmcnt(1)
    ds_read_b128 v[16:19], v3 offset:4128
    v_exp_f32 v59, v59
    v_exp_f32 v60, v60
    v_exp_f32 v61, v61
    v_exp_f32 v62, v62
    v_exp_f32 v63, v63
    v_add_u32 v5, 4128, v5
    v_add_u32 v3, 4128, v3
    v_add_u32 v4, 4128, v4
    s_add_u32 s39, s39, 1
    s_cmp_lt_u32 s39, 32
    s_cbranch_scc1 L_fb2
    s_branch L_loopend
L_code_end:
    s_endpgm
.section .rodata,"a"
.p2align 6
.amdhsa_kernel gated_mix__sliding_local_dilated__softmax_full_mha__prompt_kernel
  .amdhsa_next_free_vgpr 256
  .amdhsa_next_free_sgpr 102
  .amdhsa_accum_offset 256
  .amdhsa_group_segment_fixed_size 0
  .amdhsa_kernarg_size 80
  .amdhsa_user_sgpr_count 2
  .amdhsa_user_sgpr_kernarg_segment_ptr 1
  .amdhsa_system_sgpr_workgroup_id_x 1
.end_amdhsa_kernel
```
